```python
import torch

def _softmax(x, axis=-1):
    return torch.softmax(x, dim=axis)
def _gelu(x):
    return torch.nn.functional.gelu(x, approximate="tanh")
def _silu(x):
    return torch.nn.functional.silu(x)
def _sigmoid(x):
    return torch.sigmoid(x)
def _layernorm(x, axis=-1, eps=1e-5):
    m = x.mean(dim=axis, keepdim=True)
    v = x.var(dim=axis, keepdim=True, unbiased=False)
    return (x - m) / torch.sqrt(v + eps)
def _scatter_add(tgt, idx, src, axis=0):
    return tgt.clone().index_add_(axis, idx, src)
def _segment_sum(src, seg, n):
    out = torch.zeros((n,) + src.shape[1:], dtype=src.dtype)
    return out.index_add_(0, seg, src)
def _pad(x, pw):
    flat = tuple(v for pair in reversed(pw) for v in pair)
    return torch.nn.functional.pad(x, flat)

kernel_name = 'parallel_sum__sliding_block_cached__geglu_ffn__decode'

def setup_inputs():

    _w = (lambda a: (lambda t: t.to(torch.bfloat16) if t.is_floating_point() else t)(torch.as_tensor(a)))
    def _A_setup():
        B, Sq, D = 2, 1, 448
        Hq, Hkv, Sk, Dh = 16, 8, 32768, 256
        assert Hq % Hkv == 0, (Hq, Hkv)
        return {
            "x": _w((lambda *s: torch.randn(*s, dtype=torch.bfloat16) * 0.05)(B, Sq, D)),
            "k_cache": _w((lambda *s: torch.randn(*s, dtype=torch.bfloat16) * 3.2)(B, Hkv, Sk, Dh)),
            "v_cache": _w((lambda *s: torch.randn(*s, dtype=torch.bfloat16) * 1.6)(B, Hkv, Sk, Dh)),
            "wq": _w((lambda *s: torch.randn(*s, dtype=torch.bfloat16) * 3.2)(D, Hq * Dh) * (D ** -0.5)),
            "wo": _w((lambda *s: torch.randn(*s, dtype=torch.bfloat16) * 1.6)(Hq * Dh, D) * ((Hq * Dh) ** -0.5)),
        }
    _A_in = _A_setup()

    def _B_setup():
        B, S, D, F = 2, 1, 448, 1792
        return {
            "x": _w((lambda *s: torch.randn(*s, dtype=torch.bfloat16) * 0.05)(B, S, D)),
            "w_gate": _w((lambda *s: torch.randn(*s, dtype=torch.bfloat16) * 0.05)(D, F)),
            "w_up": _w((lambda *s: torch.randn(*s, dtype=torch.bfloat16) * 0.05)(D, F)),
            "w_down": _w((lambda *s: torch.randn(*s, dtype=torch.bfloat16) * 0.05)(F, D)),
        }
    _B_in = _B_setup()

    return {
        "A_x": _A_in["x"],
        "A_k_cache": _A_in["k_cache"],
        "A_v_cache": _A_in["v_cache"],
        "A_wq": _A_in["wq"],
        "A_wo": _A_in["wo"],
        "B_x": _B_in["x"],
        "B_w_gate": _B_in["w_gate"],
        "B_w_up": _B_in["w_up"],
        "B_w_down": _B_in["w_down"],
    }

def reference(A_x, A_k_cache, A_v_cache, A_wq, A_wo, B_x, B_w_gate, B_w_up, B_w_down):
    def _A_ref(x, k_cache, v_cache, wq, wo):
        B, Sq, D = x.shape
        Hq, Dh = 16, 256
        Hkv, Sk = k_cache.shape[1], k_cache.shape[2]
        W = min(4096, max(256, Sk // 4))
        rep = Hq // Hkv
        q = (lambda x, *d: x.permute(*d))((x @ wq).reshape(B, Sq, Hq, Dh), 0, 2, 1, 3)
        k = (lambda x, n, axis: torch.repeat_interleave(x, n, dim=axis))(k_cache[:, :, Sk - W:, :], rep, axis=1)
        v = (lambda x, n, axis: torch.repeat_interleave(x, n, dim=axis))(v_cache[:, :, Sk - W:, :], rep, axis=1)
        scores = torch.einsum("bhqd,bhkd->bhqk", q, k) * (Dh ** -0.5)
        p = _softmax(scores, axis=-1)
        o = torch.einsum("bhqk,bhkd->bhqd", p, v)
        return (lambda x, *d: x.permute(*d))(o, 0, 2, 1, 3).reshape(B, Sq, Hq * Dh) @ wo

    def _B_ref(x, w_gate, w_up, w_down):
        return (_gelu(x @ w_gate) * (x @ w_up)) @ w_down

    x = A_x
    xn = _layernorm(x, axis=-1)
    return x + _A_ref(xn, A_k_cache, A_v_cache, A_wq, A_wo) + _B_ref(xn, B_w_gate, B_w_up, B_w_down)
```

```asm
; @launch grid=(256,1,1) block=(1024,1,1) lds=138240
.amdgcn_target "amdgcn-amd-amdhsa--gfx950"
.text
.globl parallel_sum__sliding_block_cached__geglu_ffn__decode_kernel
.p2align 8
.type parallel_sum__sliding_block_cached__geglu_ffn__decode_kernel,@function
parallel_sum__sliding_block_cached__geglu_ffn__decode_kernel:
  s_load_dwordx2 s[8:9], s[0:1], 8
  s_load_dwordx2 s[12:13], s[0:1], 16
  s_load_dwordx2 s[40:41], s[0:1], 88
  v_lshrrev_b32 v1, 6, v0
  s_cmp_ge_u32 s2, 256
  s_cbranch_scc1 L_exit0
  v_readfirstlane_b32 s3, v1
  v_and_b32 v0, 63, v0
  s_and_b32 s4, s2, 7
  s_lshr_b32 s5, s2, 3
  s_cmp_lt_u32 s3, 8
  s_cbranch_scc1 L_help
  s_sub_u32 s6, s3, 8
  s_lshr_b32 s16, s5, 4
  s_and_b32 s17, s5, 15
  s_lshl_b32 s18, s16, 3
  s_add_u32 s18, s18, s4
  s_lshl_b32 s18, s18, 24
  s_lshl_b32 s19, s6, 5
  s_add_u32 s25, s6, s17
  s_and_b32 s22, s25, 15
  s_add_u32 s19, s19, s22
  s_lshl_b32 s19, s19, 12
  s_add_u32 s19, s19, s18
  s_add_u32 s19, s19, 14680064
  s_lshl_b32 s20, s6, 14
  v_lshrrev_b32 v1, 5, v0
  v_and_b32 v2, 31, v0
  v_lshlrev_b32 v3, 2, v1
  v_xor_b32 v2, v2, v3
  v_lshlrev_b32 v2, 4, v2
  v_lshl_add_u32 v8, v1, 9, v2
  s_mov_b32 m0, s20
  s_mov_b32 s10, 0x10000000
  s_mov_b32 s11, 0x20000
  v_xor_b32 v9, 128, v8
  v_xor_b32 v10, 16, v8
  v_xor_b32 v11, 144, v8
  s_waitcnt lgkmcnt(0)
  buffer_load_dwordx4 v8, s[8:11], s19 offen offset:0 nt lds
  buffer_load_dwordx4 v9, s[8:11], s19 offen offset:1024 nt lds
  buffer_load_dwordx4 v10, s[8:11], s19 offen offset:2048 nt lds
  buffer_load_dwordx4 v11, s[8:11], s19 offen offset:3072 nt lds
  s_load_dword s44, s[40:41], 0
  s_barrier
  s_branch L_tile2
L_help:
  s_mov_b32 s42, 0x400000
  s_mov_b32 s43, 0x20000
  s_cmp_lt_u32 s3, 2
  s_cbranch_scc1 L_unit
  s_cmp_eq_u32 s3, 2
  s_cbranch_scc1 L_unit_none
  s_cmp_lg_u32 s3, 3
  s_cbranch_scc1 L_h1
  v_mov_b32 v4, 0
  v_mov_b32 v5, 0
  v_mov_b32 v6, 0
  v_mov_b32 v7, 0
  v_mov_b32 v2, 132480
  ds_write_b128 v2, v[4:7]
  ds_write_b128 v2, v[4:7] offset:16
  s_getpc_b64 s[16:17]
L_pc:
  v_lshlrev_b32 v8, 7, v0
  v_add_u32 v9, 8192, v8
  v_cmp_gt_u32 vcc, L_exit0-L_pc, v9
  global_load_dword v20, v8, s[16:17]
  s_mov_b64 exec, vcc
  global_load_dword v21, v9, s[16:17]
  s_mov_b64 exec, -1
  s_waitcnt lgkmcnt(0)
  s_barrier
  s_branch L_x
L_h1:
  s_barrier
  s_branch L_T
L_unit:
  s_load_dwordx2 s[20:21], s[0:1], 0
  s_mov_b32 s22, 1792
  s_mov_b32 s23, 0x20000
  s_mov_b32 s19, 0x20000
  s_cmp_lg_u32 s3, 0
  s_cbranch_scc1 L_unit_ffn
  s_load_dwordx2 s[16:17], s[0:1], 24
  s_mov_b32 s18, 3670016
  s_mov_b32 s26, 8192
  s_and_b32 s27, s5, 7
  s_lshr_b32 s28, s5, 3
  s_lshl_b32 s29, s4, 10
  s_lshl_b32 s30, s27, 7
  s_add_u32 s29, s29, s30
  s_branch L_unit_go
L_unit_ffn:
  s_and_b32 s31, s5, 7
  s_lshr_b32 s30, s5, 3
  s_mul_i32 s32, s30, 7
  s_add_u32 s32, s32, s31
  s_cmp_gt_u32 s31, 3
  s_cselect_b32 s33, 1, 0
  s_sub_u32 s32, s32, s33
  s_add_u32 s30, s30, 28
  s_cmp_eq_u32 s31, 3
  s_cselect_b32 s32, s30, s32
  s_and_b32 s30, s4, 1
  s_lshl_b32 s31, s30, 3
  s_sub_u32 s31, 32, s31
  s_cmp_ge_u32 s32, s31
  s_cbranch_scc1 L_unit_none
  s_lshr_b32 s31, s4, 1
  s_mul_i32 s31, s31, 7
  s_lshl_b32 s30, s30, 2
  s_add_u32 s31, s31, s30
  s_lshr_b32 s27, s32, 3
  s_bfe_u32 s28, s32, 0x20001
  s_add_u32 s29, s31, s27
  s_lshl_b32 s29, s29, 7
  s_mov_b32 s18, 1605632
  s_mov_b32 s26, 3584
  s_and_b32 s38, s32, 1
  s_cbranch_scc1 L_unit_up
  s_load_dwordx2 s[16:17], s[0:1], 48
  s_branch L_unit_go
L_unit_none:
  s_barrier
  s_branch L_exit
L_unit_up:
  s_load_dwordx2 s[16:17], s[0:1], 56
L_unit_go:
  s_mul_i32 s30, s26, 112
  s_mul_i32 s30, s30, s28
  s_add_u32 s29, s29, s30
  s_mul_i32 s31, s26, 14
  v_lshrrev_b32 v3, 3, v0
  v_mul_lo_u32 v2, v3, s31
  v_and_b32 v4, 7, v0
  v_lshl_add_u32 v2, v4, 4, v2
  v_lshlrev_b32 v5, 4, v0
  v_mov_b32 v6, 2147418112
  v_cmp_gt_u32 vcc, 56, v0
  s_nop 1
  v_cndmask_b32 v5, v6, v5, vcc
  s_waitcnt lgkmcnt(0)
  buffer_load_dwordx4 v[8:11], v5, s[20:23], 0 offen
  buffer_load_dwordx4 v[12:15], v5, s[20:23], 0 offen offset:896
  s_load_dword s44, s[40:41], 0
  buffer_load_dwordx4 v[64:67], v2, s[16:19], s29 offen nt
  s_add_u32 s29, s29, s26
  buffer_load_dwordx4 v[68:71], v2, s[16:19], s29 offen nt
  s_add_u32 s29, s29, s26
  buffer_load_dwordx4 v[72:75], v2, s[16:19], s29 offen nt
  s_add_u32 s29, s29, s26
  buffer_load_dwordx4 v[76:79], v2, s[16:19], s29 offen nt
  s_add_u32 s29, s29, s26
  buffer_load_dwordx4 v[80:83], v2, s[16:19], s29 offen nt
  s_add_u32 s29, s29, s26
  buffer_load_dwordx4 v[84:87], v2, s[16:19], s29 offen nt
  s_add_u32 s29, s29, s26
  buffer_load_dwordx4 v[88:91], v2, s[16:19], s29 offen nt
  s_add_u32 s29, s29, s26
  buffer_load_dwordx4 v[92:95], v2, s[16:19], s29 offen nt
  s_add_u32 s29, s29, s26
  buffer_load_dwordx4 v[96:99], v2, s[16:19], s29 offen nt
  s_add_u32 s29, s29, s26
  buffer_load_dwordx4 v[100:103], v2, s[16:19], s29 offen nt
  s_add_u32 s29, s29, s26
  buffer_load_dwordx4 v[104:107], v2, s[16:19], s29 offen nt
  s_add_u32 s29, s29, s26
  buffer_load_dwordx4 v[108:111], v2, s[16:19], s29 offen nt
  s_add_u32 s29, s29, s26
  buffer_load_dwordx4 v[112:115], v2, s[16:19], s29 offen nt
  s_add_u32 s29, s29, s26
  buffer_load_dwordx4 v[116:119], v2, s[16:19], s29 offen nt
  s_barrier
  s_branch L_unit2
L_tile2:
  s_mov_b32 s14, 0x10000000
  s_mov_b32 s15, 0x20000
  s_mov_b32 s42, 0x400000
  s_mov_b32 s43, 0x20000
  s_add_u32 s21, s19, 65536
  v_xor_b32 v12, 32, v8
  v_xor_b32 v13, 160, v8
  v_xor_b32 v14, 48, v8
  v_xor_b32 v15, 176, v8
  s_xor_b32 s22, s19, 0x8000
  s_add_u32 s22, s22, 0x100000
  s_add_u32 s23, s22, 65536
  v_lshrrev_b32 v16, 4, v0
  v_and_b32 v1, 15, v0
  v_lshlrev_b32 v2, 4, v1
  v_lshl_add_u32 v2, v16, 9, v2
  v_and_b32 v3, 3, v1
  v_lshrrev_b32 v4, 2, v1
  v_lshlrev_b32 v5, 11, v3
  v_lshl_add_u32 v5, v4, 9, v5
  v_lshl_add_u32 v5, v4, 6, v5
  v_xor_b32 v3, v3, v16
  v_lshl_add_u32 v5, v3, 4, v5
  v_add_u32 v4, s20, v5
  v_xor_b32 v5, 64, v4
  v_xor_b32 v6, 0x80, v4
  v_xor_b32 v7, 0xc0, v4
  v_lshrrev_b32 v1, 3, v1
  v_mul_u32_u24 v3, 576, v1
  v_lshl_add_u32 v3, v16, 4, v3
  v_add_u32 v3, 131072, v3
  s_add_u32 m0, s20, 4096
  s_waitcnt vmcnt(3)
  buffer_load_dwordx4 v12, s[8:11], s21 offen offset:0 nt lds
  s_waitcnt vmcnt(3)
  buffer_load_dwordx4 v13, s[8:11], s21 offen offset:1024 nt lds
  s_waitcnt vmcnt(3)
  buffer_load_dwordx4 v14, s[8:11], s21 offen offset:2048 nt lds
  s_waitcnt vmcnt(3)
  buffer_load_dwordx4 v15, s[8:11], s21 offen offset:3072 nt lds
  s_add_u32 m0, s20, 8192
  s_waitcnt vmcnt(3)
  buffer_load_dwordx4 v8, s[8:11], s22 offen offset:0 nt lds
  s_waitcnt vmcnt(3)
  buffer_load_dwordx4 v9, s[8:11], s22 offen offset:1024 nt lds
  s_waitcnt vmcnt(3)
  buffer_load_dwordx4 v10, s[8:11], s22 offen offset:2048 nt lds
  s_waitcnt vmcnt(3)
  buffer_load_dwordx4 v11, s[8:11], s22 offen offset:3072 nt lds
  s_add_u32 m0, s20, 12288
  s_waitcnt vmcnt(3)
  buffer_load_dwordx4 v12, s[8:11], s23 offen offset:0 nt lds
  s_waitcnt vmcnt(3)
  buffer_load_dwordx4 v13, s[8:11], s23 offen offset:1024 nt lds
  s_waitcnt vmcnt(3)
  buffer_load_dwordx4 v14, s[8:11], s23 offen offset:2048 nt lds
  s_waitcnt vmcnt(3)
  buffer_load_dwordx4 v15, s[8:11], s23 offen offset:3072 nt lds
  s_waitcnt vmcnt(3)
  buffer_load_dwordx4 v[64:67], v2, s[12:15], s19 offen offset:0 nt
  s_waitcnt vmcnt(3)
  buffer_load_dwordx4 v[68:71], v2, s[12:15], s19 offen offset:256 nt
  s_waitcnt vmcnt(3)
  buffer_load_dwordx4 v[72:75], v2, s[12:15], s19 offen offset:2048 nt
  s_waitcnt vmcnt(3)
  buffer_load_dwordx4 v[76:79], v2, s[12:15], s19 offen offset:2304 nt
  s_waitcnt vmcnt(3)
  buffer_load_dwordx4 v[80:83], v2, s[12:15], s21 offen offset:0 nt
  s_waitcnt vmcnt(3)
  buffer_load_dwordx4 v[84:87], v2, s[12:15], s21 offen offset:256 nt
  s_waitcnt vmcnt(3)
  buffer_load_dwordx4 v[88:91], v2, s[12:15], s21 offen offset:2048 nt
  s_waitcnt vmcnt(3)
  buffer_load_dwordx4 v[92:95], v2, s[12:15], s21 offen offset:2304 nt
  s_waitcnt vmcnt(3)
  buffer_load_dwordx4 v[96:99], v2, s[12:15], s22 offen offset:0 nt
  buffer_load_dwordx4 v[100:103], v2, s[12:15], s22 offen offset:256 nt
  buffer_load_dwordx4 v[104:107], v2, s[12:15], s22 offen offset:2048 nt
  buffer_load_dwordx4 v[108:111], v2, s[12:15], s22 offen offset:2304 nt
  v_mov_b32 v16, 132484
  s_mov_b32 s51, 0
L_lw_1:
  ds_read_b32 v17, v16
  s_waitcnt lgkmcnt(0)
  v_readfirstlane_b32 s24, v17
  s_cmp_lg_u32 s24, 0
  s_cbranch_scc1 L_lwd_2
  s_add_u32 s51, s51, 1
  s_cmp_lt_u32 s51, 480000
  s_cbranch_scc1 L_lw_1
L_lwd_2:
  s_waitcnt vmcnt(12)
  ds_read_b128 v[16:19], v3 offset:0
  ds_read_b128 v[48:51], v4 offset:0
  ds_read_b128 v[52:55], v4 offset:8192
  ds_read_b128 v[20:23], v3 offset:64
  ds_read_b128 v[56:59], v5 offset:0
  ds_read_b128 v[60:63], v5 offset:8192
  ds_read_b128 v[24:27], v3 offset:128
  ds_read_b128 v[28:31], v3 offset:192
  ds_read_b128 v[32:35], v3 offset:256
  ds_read_b128 v[36:39], v3 offset:320
  ds_read_b128 v[40:43], v3 offset:384
  ds_read_b128 v[44:47], v3 offset:448
  s_waitcnt lgkmcnt(9)
  v_mfma_f32_16x16x32_bf16 v[8:11], v[48:51], v[16:19], 0
  v_mfma_f32_16x16x32_bf16 v[12:15], v[52:55], v[16:19], 0
  ds_read_b128 v[48:51], v6 offset:0
  ds_read_b128 v[52:55], v6 offset:8192
  s_waitcnt lgkmcnt(8)
  v_mfma_f32_16x16x32_bf16 v[8:11], v[56:59], v[20:23], v[8:11]
  v_mfma_f32_16x16x32_bf16 v[12:15], v[60:63], v[20:23], v[12:15]
  ds_read_b128 v[56:59], v7 offset:0
  ds_read_b128 v[60:63], v7 offset:8192
  s_waitcnt lgkmcnt(2)
  v_mfma_f32_16x16x32_bf16 v[8:11], v[48:51], v[24:27], v[8:11]
  v_mfma_f32_16x16x32_bf16 v[12:15], v[52:55], v[24:27], v[12:15]
  ds_read_b128 v[48:51], v4 offset:256
  ds_read_b128 v[52:55], v4 offset:8448
  s_waitcnt lgkmcnt(2)
  v_mfma_f32_16x16x32_bf16 v[8:11], v[56:59], v[28:31], v[8:11]
  v_mfma_f32_16x16x32_bf16 v[12:15], v[60:63], v[28:31], v[12:15]
  ds_read_b128 v[56:59], v5 offset:256
  ds_read_b128 v[60:63], v5 offset:8448
  s_waitcnt lgkmcnt(2)
  v_mfma_f32_16x16x32_bf16 v[8:11], v[48:51], v[32:35], v[8:11]
  v_mfma_f32_16x16x32_bf16 v[12:15], v[52:55], v[32:35], v[12:15]
  ds_read_b128 v[48:51], v6 offset:256
  ds_read_b128 v[52:55], v6 offset:8448
  s_waitcnt lgkmcnt(2)
  v_mfma_f32_16x16x32_bf16 v[8:11], v[56:59], v[36:39], v[8:11]
  v_mfma_f32_16x16x32_bf16 v[12:15], v[60:63], v[36:39], v[12:15]
  ds_read_b128 v[56:59], v7 offset:256
  ds_read_b128 v[60:63], v7 offset:8448
  s_waitcnt lgkmcnt(2)
  v_mfma_f32_16x16x32_bf16 v[8:11], v[48:51], v[40:43], v[8:11]
  v_mfma_f32_16x16x32_bf16 v[12:15], v[52:55], v[40:43], v[12:15]
  s_waitcnt lgkmcnt(0)
  v_mfma_f32_16x16x32_bf16 v[8:11], v[56:59], v[44:47], v[8:11]
  v_mfma_f32_16x16x32_bf16 v[12:15], v[60:63], v[44:47], v[12:15]
  v_lshlrev_b32 v4, 5, v1
  s_lshl_b32 s25, s6, 2
  s_add_u32 s25, s25, 132352
  v_add_u32 v5, s25, v4
  v_and_b32 v24, 1, v0
  v_lshlrev_b32 v24, 4, v24
  v_mov_b32 v25, 0xffff
  v_lshlrev_b32 v24, v24, v25
  s_mov_b32 s48, 0x03030303
  s_mov_b32 s49, 0x03030303
  v_cndmask_b32 v20, 0, v24, s[48:49]
  s_lshl_b64 s[48:49], s[48:49], 2
  v_cndmask_b32 v21, 0, v24, s[48:49]
  s_lshl_b64 s[48:49], s[48:49], 2
  v_cndmask_b32 v22, 0, v24, s[48:49]
  s_lshl_b64 s[48:49], s[48:49], 2
  v_cndmask_b32 v23, 0, v24, s[48:49]
  v_cvt_pk_bf16_f32 v16, v8, v9
  v_cvt_pk_bf16_f32 v17, v10, v11
  v_cvt_pk_bf16_f32 v18, v12, v13
  v_cvt_pk_bf16_f32 v19, v14, v15
  v_lshlrev_b32 v8, 16, v16
  v_and_b32 v9, 0xffff0000, v16
  v_lshlrev_b32 v10, 16, v17
  v_and_b32 v11, 0xffff0000, v17
  v_lshlrev_b32 v12, 16, v18
  v_and_b32 v13, 0xffff0000, v18
  v_lshlrev_b32 v14, 16, v19
  v_and_b32 v15, 0xffff0000, v19
  v_max3_f32 v6, v8, v9, v10
  v_max3_f32 v7, v11, v12, v13
  v_max3_f32 v6, v6, v14, v15
  v_max_f32 v6, v6, v7
  v_mov_b32 v7, v6
  s_nop 1
  v_permlane32_swap_b32 v6, v7
  v_max_f32 v6, v6, v7
  v_mov_b32 v7, v6
  s_nop 1
  v_permlane16_swap_b32 v6, v7
  v_max_f32 v6, v6, v7
  v_sub_f32 v8, v8, v6
  v_sub_f32 v9, v9, v6
  v_sub_f32 v10, v10, v6
  v_sub_f32 v11, v11, v6
  v_sub_f32 v12, v12, v6
  v_sub_f32 v13, v13, v6
  v_sub_f32 v14, v14, v6
  v_sub_f32 v15, v15, v6
  v_mul_f32 v8, 9.0168440056e-02, v8
  v_mul_f32 v9, 9.0168440056e-02, v9
  v_mul_f32 v10, 9.0168440056e-02, v10
  v_mul_f32 v11, 9.0168440056e-02, v11
  v_mul_f32 v12, 9.0168440056e-02, v12
  v_mul_f32 v13, 9.0168440056e-02, v13
  v_mul_f32 v14, 9.0168440056e-02, v14
  v_mul_f32 v15, 9.0168440056e-02, v15
  v_exp_f32 v8, v8
  v_exp_f32 v9, v9
  v_exp_f32 v10, v10
  v_exp_f32 v11, v11
  v_exp_f32 v12, v12
  v_exp_f32 v13, v13
  v_exp_f32 v14, v14
  v_exp_f32 v15, v15
  s_nop 0
  v_add_f32 v7, v8, v9
  v_add_f32 v3, v10, v11
  v_add_f32 v16, v12, v13
  v_add_f32 v17, v14, v15
  v_add_f32 v7, v7, v3
  v_add_f32 v16, v16, v17
  v_add_f32 v7, v7, v16
  v_mov_b32 v3, v7
  s_nop 1
  v_permlane32_swap_b32 v7, v3
  v_add_f32 v7, v7, v3
  v_mov_b32 v3, v7
  s_nop 1
  v_permlane16_swap_b32 v7, v3
  v_add_f32 v7, v7, v3
  s_mov_b64 exec, 0x101
  ds_write_b32 v5, v6
  ds_write_b32 v5, v7 offset:64
  s_mov_b64 exec, -1
  v_cvt_pk_bf16_f32 v8, v8, v8
  v_cvt_pk_bf16_f32 v9, v9, v9
  v_cvt_pk_bf16_f32 v10, v10, v10
  v_cvt_pk_bf16_f32 v11, v11, v11
  v_cvt_pk_bf16_f32 v12, v12, v12
  v_cvt_pk_bf16_f32 v13, v13, v13
  v_cvt_pk_bf16_f32 v14, v14, v14
  v_cvt_pk_bf16_f32 v15, v15, v15
  v_and_b32 v24, v8, v20
  v_and_b32 v25, v8, v21
  v_and_b32 v26, v8, v22
  v_and_b32 v27, v8, v23
  v_and_b32 v28, v9, v20
  v_and_b32 v29, v9, v21
  v_and_b32 v30, v9, v22
  v_and_b32 v31, v9, v23
  v_and_b32 v32, v10, v20
  v_and_b32 v33, v10, v21
  v_and_b32 v34, v10, v22
  v_and_b32 v35, v10, v23
  v_and_b32 v36, v11, v20
  v_and_b32 v37, v11, v21
  v_and_b32 v38, v11, v22
  v_and_b32 v39, v11, v23
  v_and_b32 v40, v12, v20
  v_and_b32 v41, v12, v21
  v_and_b32 v42, v12, v22
  v_and_b32 v43, v12, v23
  v_and_b32 v44, v13, v20
  v_and_b32 v45, v13, v21
  v_and_b32 v46, v13, v22
  v_and_b32 v47, v13, v23
  v_and_b32 v48, v14, v20
  v_and_b32 v49, v14, v21
  v_and_b32 v50, v14, v22
  v_and_b32 v51, v14, v23
  v_and_b32 v52, v15, v20
  v_and_b32 v53, v15, v21
  v_and_b32 v54, v15, v22
  v_and_b32 v55, v15, v23
  buffer_load_dwordx4 v[112:115], v2, s[12:15], s23 offen offset:0 nt
  s_waitcnt vmcnt(3)
  buffer_load_dwordx4 v[116:119], v2, s[12:15], s23 offen offset:256 nt
  s_waitcnt vmcnt(3)
  buffer_load_dwordx4 v[120:123], v2, s[12:15], s23 offen offset:2048 nt
  s_waitcnt vmcnt(3)
  buffer_load_dwordx4 v[124:127], v2, s[12:15], s23 offen offset:2304 nt
  v_and_b32 v2, 15, v0
  v_lshlrev_b32 v2, 5, v2
  v_bfe_u32 v3, v0, 4, 1
  v_lshl_add_u32 v2, v3, 4, v2
  v_lshrrev_b32 v3, 5, v0
  v_lshl_add_u32 v2, v3, 9, v2
  s_lshl_b32 s21, s6, 11
  v_add_u32 v2, s21, v2
  v_mov_b32 v4, 132488
  s_lshl_b32 s28, 1, s6
  v_mov_b32 v5, s28
  s_waitcnt lgkmcnt(0)
  s_barrier
  s_mul_i32 s44, s44, 1664525
  s_add_u32 s44, s44, 1013904223
  s_not_b32 s45, s44
  s_sub_u32 s29, s6, 0
  s_cmp_ge_u32 s29, 2
  s_cbranch_scc1 L_tile_pv
  v_lshlrev_b32 v3, 5, v3
  v_add_u32 v3, 132352, v3
  v_mov_b32 v7, 132480
  ds_read_b128 v[8:11], v3
  ds_read_b128 v[12:15], v3 offset:16
  ds_read_b32 v7, v7
  s_waitcnt lgkmcnt(0)
  v_readfirstlane_b32 s24, v7
  v_max3_f32 v6, v8, v9, v10
  v_max3_f32 v7, v11, v12, v13
  v_max3_f32 v6, v6, v14, v15
  v_max_f32 v6, v6, v7
  v_sub_f32 v8, v8, v6
  v_sub_f32 v9, v9, v6
  v_sub_f32 v10, v10, v6
  v_sub_f32 v11, v11, v6
  v_sub_f32 v12, v12, v6
  v_sub_f32 v13, v13, v6
  v_sub_f32 v14, v14, v6
  v_sub_f32 v15, v15, v6
  v_mul_f32 v8, 9.0168440056e-02, v8
  v_mul_f32 v9, 9.0168440056e-02, v9
  v_mul_f32 v10, 9.0168440056e-02, v10
  v_mul_f32 v11, 9.0168440056e-02, v11
  v_mul_f32 v12, 9.0168440056e-02, v12
  v_mul_f32 v13, 9.0168440056e-02, v13
  v_mul_f32 v14, 9.0168440056e-02, v14
  v_mul_f32 v15, 9.0168440056e-02, v15
  v_exp_f32 v8, v8
  v_exp_f32 v9, v9
  v_exp_f32 v10, v10
  v_exp_f32 v11, v11
  v_exp_f32 v12, v12
  v_exp_f32 v13, v13
  v_exp_f32 v14, v14
  v_exp_f32 v15, v15
  s_and_b32 s46, s44, 0xff
  v_mov_b32 v16, s46
  s_bfe_u32 s46, s44, 0x80008
  v_mov_b32 v17, s46
  s_bfe_u32 s46, s44, 0x80010
  v_mov_b32 v18, s46
  s_lshr_b32 s46, s44, 24
  v_mov_b32 v19, s46
  s_mov_b32 s47, 0xffffff00
  v_lshrrev_b32 v3, 5, v0
  v_lshlrev_b32 v3, 14, v3
  v_bfe_u32 v7, v0, 2, 3
  v_lshl_add_u32 v3, v7, 10, v3
  v_and_b32 v7, 3, v0
  v_lshl_add_u32 v3, v7, 8, v3
  s_lshl_b32 s21, s4, 16
  s_lshl_b32 s22, s16, 15
  s_add_u32 s21, s21, s22
  s_lshl_b32 s22, s29, 13
  s_add_u32 s21, s21, s22
  s_lshl_b32 s22, s17, 4
  s_add_u32 s21, s21, s22
  s_add_u32 s21, s21, 409600
  s_lshl_b32 s22, s29, 10
  v_lshlrev_b32 v1, 4, v0
  v_add_u32 v1, s22, v1
L_tile_pv:
  s_setprio 1
  s_waitcnt vmcnt(14)
  v_mfma_f32_16x16x32_bf16 v[56:59], v[24:27], v[64:67], 0
  v_mfma_f32_16x16x32_bf16 v[60:63], v[24:27], v[68:71], 0
  s_waitcnt vmcnt(12)
  v_mfma_f32_16x16x32_bf16 v[56:59], v[28:31], v[72:75], v[56:59]
  v_mfma_f32_16x16x32_bf16 v[60:63], v[28:31], v[76:79], v[60:63]
  s_waitcnt vmcnt(10)
  v_mfma_f32_16x16x32_bf16 v[56:59], v[32:35], v[80:83], v[56:59]
  v_mfma_f32_16x16x32_bf16 v[60:63], v[32:35], v[84:87], v[60:63]
  s_waitcnt vmcnt(8)
  v_mfma_f32_16x16x32_bf16 v[56:59], v[36:39], v[88:91], v[56:59]
  v_mfma_f32_16x16x32_bf16 v[60:63], v[36:39], v[92:95], v[60:63]
  s_waitcnt vmcnt(6)
  v_mfma_f32_16x16x32_bf16 v[56:59], v[40:43], v[96:99], v[56:59]
  v_mfma_f32_16x16x32_bf16 v[60:63], v[40:43], v[100:103], v[60:63]
  s_waitcnt vmcnt(4)
  v_mfma_f32_16x16x32_bf16 v[56:59], v[44:47], v[104:107], v[56:59]
  v_mfma_f32_16x16x32_bf16 v[60:63], v[44:47], v[108:111], v[60:63]
  s_waitcnt vmcnt(2)
  v_mfma_f32_16x16x32_bf16 v[56:59], v[48:51], v[112:115], v[56:59]
  v_mfma_f32_16x16x32_bf16 v[60:63], v[48:51], v[116:119], v[60:63]
  s_waitcnt vmcnt(0)
  v_mfma_f32_16x16x32_bf16 v[56:59], v[52:55], v[120:123], v[56:59]
  v_mfma_f32_16x16x32_bf16 v[60:63], v[52:55], v[124:127], v[60:63]
  s_nop 6
  ds_write_b128 v2, v[56:59] offset:0
  ds_write_b128 v2, v[60:63] offset:1024
  s_mov_b64 exec, 1
  ds_or_b32 v4, v5
  s_mov_b64 exec, -1
  s_cmp_ge_u32 s29, 2
  s_cbranch_scc1 L_exit
  s_lshl_b32 s28, 0x100, s29
  v_mov_b32 v5, s28
  s_mov_b32 s51, 0
L_owait0:
  ds_read_b32 v7, v4
  s_add_u32 s51, s51, 1
  s_waitcnt lgkmcnt(0)
  v_not_b32 v7, v7
  v_and_b32 v7, 15, v7
  v_cmp_ne_u32 vcc, 0, v7
  s_cbranch_vccz L_ogo0
  s_cmp_lt_u32 s51, 480000
  s_cbranch_scc1 L_owait0
L_ogo0:
  ds_read_b128 v[64:67], v1 offset:0
  ds_read_b128 v[68:71], v1 offset:2048
  ds_read_b128 v[72:75], v1 offset:4096
  ds_read_b128 v[76:79], v1 offset:6144
  s_waitcnt lgkmcnt(3)
  v_mul_f32 v56, v64, v8
  v_mul_f32 v57, v65, v8
  v_mul_f32 v58, v66, v8
  v_mul_f32 v59, v67, v8
  s_waitcnt lgkmcnt(2)
  v_mul_f32 v60, v68, v9
  v_mul_f32 v61, v69, v9
  v_mul_f32 v62, v70, v9
  v_mul_f32 v63, v71, v9
  s_waitcnt lgkmcnt(1)
  v_fmac_f32 v56, v72, v10
  v_fmac_f32 v57, v73, v10
  v_fmac_f32 v58, v74, v10
  v_fmac_f32 v59, v75, v10
  s_waitcnt lgkmcnt(0)
  v_fmac_f32 v60, v76, v11
  v_fmac_f32 v61, v77, v11
  v_fmac_f32 v62, v78, v11
  v_fmac_f32 v63, v79, v11
L_owait1:
  ds_read_b32 v7, v4
  s_add_u32 s51, s51, 1
  s_waitcnt lgkmcnt(0)
  v_not_b32 v7, v7
  v_and_b32 v7, 240, v7
  v_cmp_ne_u32 vcc, 0, v7
  s_cbranch_vccz L_ogo1
  s_cmp_lt_u32 s51, 480000
  s_cbranch_scc1 L_owait1
L_ogo1:
  ds_read_b128 v[80:83], v1 offset:8192
  ds_read_b128 v[84:87], v1 offset:10240
  ds_read_b128 v[88:91], v1 offset:12288
  ds_read_b128 v[92:95], v1 offset:14336
  s_waitcnt lgkmcnt(3)
  v_fmac_f32 v56, v80, v12
  v_fmac_f32 v57, v81, v12
  v_fmac_f32 v58, v82, v12
  v_fmac_f32 v59, v83, v12
  s_waitcnt lgkmcnt(2)
  v_fmac_f32 v60, v84, v13
  v_fmac_f32 v61, v85, v13
  v_fmac_f32 v62, v86, v13
  v_fmac_f32 v63, v87, v13
  s_waitcnt lgkmcnt(1)
  v_fmac_f32 v56, v88, v14
  v_fmac_f32 v57, v89, v14
  v_fmac_f32 v58, v90, v14
  v_fmac_f32 v59, v91, v14
  s_waitcnt lgkmcnt(0)
  v_fmac_f32 v60, v92, v15
  v_fmac_f32 v61, v93, v15
  v_fmac_f32 v62, v94, v15
  v_fmac_f32 v63, v95, v15
  v_add_f32 v56, v56, v60
  v_add_f32 v57, v57, v61
  v_add_f32 v58, v58, v62
  v_add_f32 v59, v59, v63
  v_and_or_b32 v56, v56, s47, v16
  v_and_or_b32 v57, v57, s47, v17
  v_and_or_b32 v58, v58, s47, v18
  v_and_or_b32 v59, v59, s47, v19
  s_cmp_eq_u32 s24, 1
  s_cbranch_scc1 L_tile_local
  buffer_store_dwordx4 v[56:59], v3, s[40:43], s21 offen sc1
  s_mov_b64 exec, 1
  ds_or_b32 v4, v5
  s_endpgm
L_tile_local:
  buffer_store_dwordx4 v[56:59], v3, s[40:43], s21 offen
  s_mov_b64 exec, 1
  ds_or_b32 v4, v5
  s_endpgm
L_unit2:
  s_waitcnt vmcnt(14)
  v_lshlrev_b32 v16, 16, v8
  v_and_b32 v17, 0xffff0000, v8
  v_lshlrev_b32 v18, 16, v9
  v_and_b32 v19, 0xffff0000, v9
  v_lshlrev_b32 v20, 16, v10
  v_and_b32 v21, 0xffff0000, v10
  v_lshlrev_b32 v22, 16, v11
  v_and_b32 v23, 0xffff0000, v11
  v_lshlrev_b32 v24, 16, v12
  v_and_b32 v25, 0xffff0000, v12
  v_lshlrev_b32 v26, 16, v13
  v_and_b32 v27, 0xffff0000, v13
  v_lshlrev_b32 v28, 16, v14
  v_and_b32 v29, 0xffff0000, v14
  v_lshlrev_b32 v30, 16, v15
  v_and_b32 v31, 0xffff0000, v15
  v_add_f32 v32, v16, v17
  v_add_f32 v34, v18, v19
  v_add_f32 v36, v20, v21
  v_add_f32 v38, v22, v23
  v_add_f32 v33, v24, v25
  v_add_f32 v35, v26, v27
  v_add_f32 v37, v28, v29
  v_add_f32 v39, v30, v31
  v_add_f32 v32, v32, v34
  v_add_f32 v36, v36, v38
  v_add_f32 v33, v33, v35
  v_add_f32 v37, v37, v39
  v_add_f32 v32, v32, v36
  v_add_f32 v33, v33, v37
  s_nop 0
  v_add_f32_dpp v32, v32, v32 quad_perm:[1,0,3,2] row_mask:0xf bank_mask:0xf
  v_add_f32_dpp v33, v33, v33 quad_perm:[1,0,3,2] row_mask:0xf bank_mask:0xf
  s_nop 0
  v_add_f32_dpp v32, v32, v32 quad_perm:[2,3,0,1] row_mask:0xf bank_mask:0xf
  v_add_f32_dpp v33, v33, v33 quad_perm:[2,3,0,1] row_mask:0xf bank_mask:0xf
  s_nop 0
  v_add_f32_dpp v32, v32, v32 row_half_mirror row_mask:0xf bank_mask:0xf
  v_add_f32_dpp v33, v33, v33 row_half_mirror row_mask:0xf bank_mask:0xf
  s_nop 0
  v_add_f32_dpp v32, v32, v32 row_mirror row_mask:0xf bank_mask:0xf
  v_add_f32_dpp v33, v33, v33 row_mirror row_mask:0xf bank_mask:0xf
  v_mov_b32 v34, v32
  v_mov_b32 v35, v33
  s_nop 0
  v_permlane16_swap_b32 v32, v34
  v_permlane16_swap_b32 v33, v35
  v_add_f32 v32, v32, v34
  v_add_f32 v33, v33, v35
  v_mov_b32 v34, v32
  v_mov_b32 v35, v33
  s_nop 0
  v_permlane32_swap_b32 v32, v34
  v_permlane32_swap_b32 v33, v35
  v_add_f32 v32, v32, v34
  v_add_f32 v33, v33, v35
  v_mul_f32 v32, 2.2321428571e-03, v32
  v_mul_f32 v33, 2.2321428571e-03, v33
  v_mov_b32 v36, 0
  v_mov_b32 v37, 0
  s_mov_b32 exec_hi, 0x00ffffff
  v_sub_f32 v38, v16, v32
  v_sub_f32 v39, v24, v33
  v_fmac_f32 v36, v38, v38
  v_fmac_f32 v37, v39, v39
  v_sub_f32 v38, v17, v32
  v_sub_f32 v39, v25, v33
  v_fmac_f32 v36, v38, v38
  v_fmac_f32 v37, v39, v39
  v_sub_f32 v38, v18, v32
  v_sub_f32 v39, v26, v33
  v_fmac_f32 v36, v38, v38
  v_fmac_f32 v37, v39, v39
  v_sub_f32 v38, v19, v32
  v_sub_f32 v39, v27, v33
  v_fmac_f32 v36, v38, v38
  v_fmac_f32 v37, v39, v39
  v_sub_f32 v38, v20, v32
  v_sub_f32 v39, v28, v33
  v_fmac_f32 v36, v38, v38
  v_fmac_f32 v37, v39, v39
  v_sub_f32 v38, v21, v32
  v_sub_f32 v39, v29, v33
  v_fmac_f32 v36, v38, v38
  v_fmac_f32 v37, v39, v39
  v_sub_f32 v38, v22, v32
  v_sub_f32 v39, v30, v33
  v_fmac_f32 v36, v38, v38
  v_fmac_f32 v37, v39, v39
  v_sub_f32 v38, v23, v32
  v_sub_f32 v39, v31, v33
  v_fmac_f32 v36, v38, v38
  v_fmac_f32 v37, v39, v39
  s_mov_b32 exec_hi, -1
  v_add_f32_dpp v36, v36, v36 quad_perm:[1,0,3,2] row_mask:0xf bank_mask:0xf
  v_add_f32_dpp v37, v37, v37 quad_perm:[1,0,3,2] row_mask:0xf bank_mask:0xf
  s_nop 0
  v_add_f32_dpp v36, v36, v36 quad_perm:[2,3,0,1] row_mask:0xf bank_mask:0xf
  v_add_f32_dpp v37, v37, v37 quad_perm:[2,3,0,1] row_mask:0xf bank_mask:0xf
  s_nop 0
  v_add_f32_dpp v36, v36, v36 row_half_mirror row_mask:0xf bank_mask:0xf
  v_add_f32_dpp v37, v37, v37 row_half_mirror row_mask:0xf bank_mask:0xf
  s_nop 0
  v_add_f32_dpp v36, v36, v36 row_mirror row_mask:0xf bank_mask:0xf
  v_add_f32_dpp v37, v37, v37 row_mirror row_mask:0xf bank_mask:0xf
  v_mov_b32 v34, v36
  v_mov_b32 v35, v37
  s_nop 0
  v_permlane16_swap_b32 v36, v34
  v_permlane16_swap_b32 v37, v35
  v_add_f32 v36, v36, v34
  v_add_f32 v37, v37, v35
  v_mov_b32 v34, v36
  v_mov_b32 v35, v37
  s_nop 0
  v_permlane32_swap_b32 v36, v34
  v_permlane32_swap_b32 v37, v35
  v_add_f32 v36, v36, v34
  v_add_f32 v37, v37, v35
  v_mul_f32 v36, 2.2321428571e-03, v36
  v_mul_f32 v37, 2.2321428571e-03, v37
  v_cvt_pk_bf16_f32 v34, v36, v37
  v_cvt_pk_bf16_f32 v35, v32, v33
  v_lshlrev_b32 v36, 16, v34
  v_and_b32 v37, 0xffff0000, v34
  v_lshlrev_b32 v32, 16, v35
  v_and_b32 v33, 0xffff0000, v35
  v_add_f32 v36, 0x3727c5ac, v36
  v_add_f32 v37, 0x3727c5ac, v37
  v_cvt_pk_bf16_f32 v34, v36, v37
  v_lshlrev_b32 v36, 16, v34
  v_and_b32 v37, 0xffff0000, v34
  v_sqrt_f32 v36, v36
  v_sqrt_f32 v37, v37
  s_nop 0
  v_cvt_pk_bf16_f32 v34, v36, v37
  v_lshlrev_b32 v36, 16, v34
  v_and_b32 v37, 0xffff0000, v34
  v_rcp_f32 v38, v36
  v_rcp_f32 v39, v37
  v_sub_f32 v16, v16, v32
  v_sub_f32 v17, v17, v32
  v_sub_f32 v18, v18, v32
  v_sub_f32 v19, v19, v32
  v_sub_f32 v20, v20, v32
  v_sub_f32 v21, v21, v32
  v_sub_f32 v22, v22, v32
  v_sub_f32 v23, v23, v32
  v_cvt_pk_bf16_f32 v40, v16, v17
  v_cvt_pk_bf16_f32 v41, v18, v19
  v_cvt_pk_bf16_f32 v42, v20, v21
  v_cvt_pk_bf16_f32 v43, v22, v23
  v_lshlrev_b32 v16, 16, v40
  v_and_b32 v17, 0xffff0000, v40
  v_lshlrev_b32 v18, 16, v41
  v_and_b32 v19, 0xffff0000, v41
  v_lshlrev_b32 v20, 16, v42
  v_and_b32 v21, 0xffff0000, v42
  v_lshlrev_b32 v22, 16, v43
  v_and_b32 v23, 0xffff0000, v43
  v_mul_f32 v44, v16, v38
  v_mul_f32 v45, v17, v38
  v_mul_f32 v46, v18, v38
  v_mul_f32 v47, v19, v38
  v_mul_f32 v48, v20, v38
  v_mul_f32 v49, v21, v38
  v_mul_f32 v50, v22, v38
  v_mul_f32 v51, v23, v38
  v_fma_f32 v16, -v44, v36, v16
  v_fma_f32 v17, -v45, v36, v17
  v_fma_f32 v18, -v46, v36, v18
  v_fma_f32 v19, -v47, v36, v19
  v_fma_f32 v20, -v48, v36, v20
  v_fma_f32 v21, -v49, v36, v21
  v_fma_f32 v22, -v50, v36, v22
  v_fma_f32 v23, -v51, v36, v23
  v_fmac_f32 v44, v16, v38
  v_fmac_f32 v45, v17, v38
  v_fmac_f32 v46, v18, v38
  v_fmac_f32 v47, v19, v38
  v_fmac_f32 v48, v20, v38
  v_fmac_f32 v49, v21, v38
  v_fmac_f32 v50, v22, v38
  v_fmac_f32 v51, v23, v38
  v_cvt_pk_bf16_f32 v8, v44, v45
  v_cvt_pk_bf16_f32 v9, v46, v47
  v_cvt_pk_bf16_f32 v10, v48, v49
  v_cvt_pk_bf16_f32 v11, v50, v51
  v_sub_f32 v24, v24, v33
  v_sub_f32 v25, v25, v33
  v_sub_f32 v26, v26, v33
  v_sub_f32 v27, v27, v33
  v_sub_f32 v28, v28, v33
  v_sub_f32 v29, v29, v33
  v_sub_f32 v30, v30, v33
  v_sub_f32 v31, v31, v33
  v_cvt_pk_bf16_f32 v40, v24, v25
  v_cvt_pk_bf16_f32 v41, v26, v27
  v_cvt_pk_bf16_f32 v42, v28, v29
  v_cvt_pk_bf16_f32 v43, v30, v31
  v_lshlrev_b32 v24, 16, v40
  v_and_b32 v25, 0xffff0000, v40
  v_lshlrev_b32 v26, 16, v41
  v_and_b32 v27, 0xffff0000, v41
  v_lshlrev_b32 v28, 16, v42
  v_and_b32 v29, 0xffff0000, v42
  v_lshlrev_b32 v30, 16, v43
  v_and_b32 v31, 0xffff0000, v43
  v_mul_f32 v44, v24, v39
  v_mul_f32 v45, v25, v39
  v_mul_f32 v46, v26, v39
  v_mul_f32 v47, v27, v39
  v_mul_f32 v48, v28, v39
  v_mul_f32 v49, v29, v39
  v_mul_f32 v50, v30, v39
  v_mul_f32 v51, v31, v39
  v_fma_f32 v24, -v44, v37, v24
  v_fma_f32 v25, -v45, v37, v25
  v_fma_f32 v26, -v46, v37, v26
  v_fma_f32 v27, -v47, v37, v27
  v_fma_f32 v28, -v48, v37, v28
  v_fma_f32 v29, -v49, v37, v29
  v_fma_f32 v30, -v50, v37, v30
  v_fma_f32 v31, -v51, v37, v31
  v_fmac_f32 v44, v24, v39
  v_fmac_f32 v45, v25, v39
  v_fmac_f32 v46, v26, v39
  v_fmac_f32 v47, v27, v39
  v_fmac_f32 v48, v28, v39
  v_fmac_f32 v49, v29, v39
  v_fmac_f32 v50, v30, v39
  v_fmac_f32 v51, v31, v39
  v_cvt_pk_bf16_f32 v12, v44, v45
  v_cvt_pk_bf16_f32 v13, v46, v47
  v_cvt_pk_bf16_f32 v14, v48, v49
  v_cvt_pk_bf16_f32 v15, v50, v51
  s_mul_i32 s31, s3, 1792
  s_add_u32 s31, s31, 132608
  v_lshl_add_u32 v5, v0, 4, s31
  s_mov_b32 exec_hi, 0x00ffffff
  ds_write_b128 v5, v[8:11]
  ds_write_b128 v5, v[12:15] offset:896
  s_mov_b32 exec_hi, -1
  s_mul_i32 s32, s28, 224
  s_add_u32 s31, s31, s32
  v_mul_u32_u24 v5, 28, v3
  v_add_u32 v5, s31, v5
  s_waitcnt lgkmcnt(0)
  ds_read2_b32 v[32:33], v5 offset0:0 offset1:1
  ds_read2_b32 v[34:35], v5 offset0:2 offset1:3
  ds_read2_b32 v[36:37], v5 offset0:4 offset1:5
  ds_read_b32 v38, v5 offset:24
  ds_read2_b32 v[40:41], v5 offset0:224 offset1:225
  ds_read2_b32 v[42:43], v5 offset0:226 offset1:227
  ds_read2_b32 v[44:45], v5 offset0:228 offset1:229
  ds_read_b32 v46, v5 offset:920
  v_and_b32 v52, 1, v0
  v_lshlrev_b32 v52, 4, v52
  v_mov_b32 v53, 0xffff
  v_lshlrev_b32 v52, v52, v53
  s_mov_b32 s48, 0x03030303
  s_mov_b32 s49, 0x03030303
  v_cndmask_b32 v48, 0, v52, s[48:49]
  s_lshl_b64 s[48:49], s[48:49], 2
  v_cndmask_b32 v49, 0, v52, s[48:49]
  s_lshl_b64 s[48:49], s[48:49], 2
  v_cndmask_b32 v50, 0, v52, s[48:49]
  s_lshl_b64 s[48:49], s[48:49], 2
  v_cndmask_b32 v51, 0, v52, s[48:49]
  s_mul_i32 s44, s44, 1664525
  s_add_u32 s44, s44, 1013904223
  s_not_b32 s45, s44
  s_mov_b32 s32, 0x01000100
  s_mov_b32 s33, 0x03020302
  s_waitcnt lgkmcnt(0)
  v_perm_b32 v52, v32, v32, s32
  v_perm_b32 v53, v40, v40, s32
  v_and_b32 v56, v52, v48
  v_and_b32 v57, v52, v49
  v_and_b32 v58, v52, v50
  v_and_b32 v59, v52, v51
  v_and_b32 v60, v53, v48
  v_and_b32 v61, v53, v49
  v_and_b32 v62, v53, v50
  v_and_b32 v63, v53, v51
  s_waitcnt vmcnt(13)
  v_mfma_f32_16x16x32_bf16 v[120:123], v[56:59], v[64:67], 0
  v_mfma_f32_16x16x32_bf16 v[124:127], v[60:63], v[64:67], 0
  v_perm_b32 v52, v32, v32, s33
  v_perm_b32 v53, v40, v40, s33
  v_and_b32 v56, v52, v48
  v_and_b32 v57, v52, v49
  v_and_b32 v58, v52, v50
  v_and_b32 v59, v52, v51
  v_and_b32 v60, v53, v48
  v_and_b32 v61, v53, v49
  v_and_b32 v62, v53, v50
  v_and_b32 v63, v53, v51
  s_waitcnt vmcnt(12)
  v_mfma_f32_16x16x32_bf16 v[120:123], v[56:59], v[68:71], v[120:123]
  v_mfma_f32_16x16x32_bf16 v[124:127], v[60:63], v[68:71], v[124:127]
  v_perm_b32 v52, v33, v33, s32
  v_perm_b32 v53, v41, v41, s32
  v_and_b32 v56, v52, v48
  v_and_b32 v57, v52, v49
  v_and_b32 v58, v52, v50
  v_and_b32 v59, v52, v51
  v_and_b32 v60, v53, v48
  v_and_b32 v61, v53, v49
  v_and_b32 v62, v53, v50
  v_and_b32 v63, v53, v51
  s_waitcnt vmcnt(11)
  v_mfma_f32_16x16x32_bf16 v[120:123], v[56:59], v[72:75], v[120:123]
  v_mfma_f32_16x16x32_bf16 v[124:127], v[60:63], v[72:75], v[124:127]
  v_perm_b32 v52, v33, v33, s33
  v_perm_b32 v53, v41, v41, s33
  v_and_b32 v56, v52, v48
  v_and_b32 v57, v52, v49
  v_and_b32 v58, v52, v50
  v_and_b32 v59, v52, v51
  v_and_b32 v60, v53, v48
  v_and_b32 v61, v53, v49
  v_and_b32 v62, v53, v50
  v_and_b32 v63, v53, v51
  s_waitcnt vmcnt(10)
  v_mfma_f32_16x16x32_bf16 v[120:123], v[56:59], v[76:79], v[120:123]
  v_mfma_f32_16x16x32_bf16 v[124:127], v[60:63], v[76:79], v[124:127]
  v_perm_b32 v52, v34, v34, s32
  v_perm_b32 v53, v42, v42, s32
  v_and_b32 v56, v52, v48
  v_and_b32 v57, v52, v49
  v_and_b32 v58, v52, v50
  v_and_b32 v59, v52, v51
  v_and_b32 v60, v53, v48
  v_and_b32 v61, v53, v49
  v_and_b32 v62, v53, v50
  v_and_b32 v63, v53, v51
  s_waitcnt vmcnt(9)
  v_mfma_f32_16x16x32_bf16 v[120:123], v[56:59], v[80:83], v[120:123]
  v_mfma_f32_16x16x32_bf16 v[124:127], v[60:63], v[80:83], v[124:127]
  v_perm_b32 v52, v34, v34, s33
  v_perm_b32 v53, v42, v42, s33
  v_and_b32 v56, v52, v48
  v_and_b32 v57, v52, v49
  v_and_b32 v58, v52, v50
  v_and_b32 v59, v52, v51
  v_and_b32 v60, v53, v48
  v_and_b32 v61, v53, v49
  v_and_b32 v62, v53, v50
  v_and_b32 v63, v53, v51
  s_waitcnt vmcnt(8)
  v_mfma_f32_16x16x32_bf16 v[120:123], v[56:59], v[84:87], v[120:123]
  v_mfma_f32_16x16x32_bf16 v[124:127], v[60:63], v[84:87], v[124:127]
  v_perm_b32 v52, v35, v35, s32
  v_perm_b32 v53, v43, v43, s32
  v_and_b32 v56, v52, v48
  v_and_b32 v57, v52, v49
  v_and_b32 v58, v52, v50
  v_and_b32 v59, v52, v51
  v_and_b32 v60, v53, v48
  v_and_b32 v61, v53, v49
  v_and_b32 v62, v53, v50
  v_and_b32 v63, v53, v51
  s_waitcnt vmcnt(7)
  v_mfma_f32_16x16x32_bf16 v[120:123], v[56:59], v[88:91], v[120:123]
  v_mfma_f32_16x16x32_bf16 v[124:127], v[60:63], v[88:91], v[124:127]
  v_perm_b32 v52, v35, v35, s33
  v_perm_b32 v53, v43, v43, s33
  v_and_b32 v56, v52, v48
  v_and_b32 v57, v52, v49
  v_and_b32 v58, v52, v50
  v_and_b32 v59, v52, v51
  v_and_b32 v60, v53, v48
  v_and_b32 v61, v53, v49
  v_and_b32 v62, v53, v50
  v_and_b32 v63, v53, v51
  s_waitcnt vmcnt(6)
  v_mfma_f32_16x16x32_bf16 v[120:123], v[56:59], v[92:95], v[120:123]
  v_mfma_f32_16x16x32_bf16 v[124:127], v[60:63], v[92:95], v[124:127]
  v_perm_b32 v52, v36, v36, s32
  v_perm_b32 v53, v44, v44, s32
  v_and_b32 v56, v52, v48
  v_and_b32 v57, v52, v49
  v_and_b32 v58, v52, v50
  v_and_b32 v59, v52, v51
  v_and_b32 v60, v53, v48
  v_and_b32 v61, v53, v49
  v_and_b32 v62, v53, v50
  v_and_b32 v63, v53, v51
  s_waitcnt vmcnt(5)
  v_mfma_f32_16x16x32_bf16 v[120:123], v[56:59], v[96:99], v[120:123]
  v_mfma_f32_16x16x32_bf16 v[124:127], v[60:63], v[96:99], v[124:127]
  v_perm_b32 v52, v36, v36, s33
  v_perm_b32 v53, v44, v44, s33
  v_and_b32 v56, v52, v48
  v_and_b32 v57, v52, v49
  v_and_b32 v58, v52, v50
  v_and_b32 v59, v52, v51
  v_and_b32 v60, v53, v48
  v_and_b32 v61, v53, v49
  v_and_b32 v62, v53, v50
  v_and_b32 v63, v53, v51
  s_waitcnt vmcnt(4)
  v_mfma_f32_16x16x32_bf16 v[120:123], v[56:59], v[100:103], v[120:123]
  v_mfma_f32_16x16x32_bf16 v[124:127], v[60:63], v[100:103], v[124:127]
  v_perm_b32 v52, v37, v37, s32
  v_perm_b32 v53, v45, v45, s32
  v_and_b32 v56, v52, v48
  v_and_b32 v57, v52, v49
  v_and_b32 v58, v52, v50
  v_and_b32 v59, v52, v51
  v_and_b32 v60, v53, v48
  v_and_b32 v61, v53, v49
  v_and_b32 v62, v53, v50
  v_and_b32 v63, v53, v51
  s_waitcnt vmcnt(3)
  v_mfma_f32_16x16x32_bf16 v[120:123], v[56:59], v[104:107], v[120:123]
  v_mfma_f32_16x16x32_bf16 v[124:127], v[60:63], v[104:107], v[124:127]
  v_perm_b32 v52, v37, v37, s33
  v_perm_b32 v53, v45, v45, s33
  v_and_b32 v56, v52, v48
  v_and_b32 v57, v52, v49
  v_and_b32 v58, v52, v50
  v_and_b32 v59, v52, v51
  v_and_b32 v60, v53, v48
  v_and_b32 v61, v53, v49
  v_and_b32 v62, v53, v50
  v_and_b32 v63, v53, v51
  s_waitcnt vmcnt(2)
  v_mfma_f32_16x16x32_bf16 v[120:123], v[56:59], v[108:111], v[120:123]
  v_mfma_f32_16x16x32_bf16 v[124:127], v[60:63], v[108:111], v[124:127]
  v_perm_b32 v52, v38, v38, s32
  v_perm_b32 v53, v46, v46, s32
  v_and_b32 v56, v52, v48
  v_and_b32 v57, v52, v49
  v_and_b32 v58, v52, v50
  v_and_b32 v59, v52, v51
  v_and_b32 v60, v53, v48
  v_and_b32 v61, v53, v49
  v_and_b32 v62, v53, v50
  v_and_b32 v63, v53, v51
  s_waitcnt vmcnt(1)
  v_mfma_f32_16x16x32_bf16 v[120:123], v[56:59], v[112:115], v[120:123]
  v_mfma_f32_16x16x32_bf16 v[124:127], v[60:63], v[112:115], v[124:127]
  v_perm_b32 v52, v38, v38, s33
  v_perm_b32 v53, v46, v46, s33
  v_and_b32 v56, v52, v48
  v_and_b32 v57, v52, v49
  v_and_b32 v58, v52, v50
  v_and_b32 v59, v52, v51
  v_and_b32 v60, v53, v48
  v_and_b32 v61, v53, v49
  v_and_b32 v62, v53, v50
  v_and_b32 v63, v53, v51
  s_waitcnt vmcnt(0)
  v_mfma_f32_16x16x32_bf16 v[120:123], v[56:59], v[116:119], v[120:123]
  v_mfma_f32_16x16x32_bf16 v[124:127], v[60:63], v[116:119], v[124:127]
  v_lshrrev_b32 v5, 5, v0
  v_bfe_u32 v6, v0, 4, 1
  v_lshlrev_b32 v6, 7, v6
  v_lshl_add_u32 v6, v4, 4, v6
  s_nop 3
  v_permlane32_swap_b32 v120, v124
  v_permlane32_swap_b32 v121, v125
  v_permlane32_swap_b32 v122, v126
  v_permlane32_swap_b32 v123, v127
  s_cmp_lg_u32 s3, 0
  s_cbranch_scc1 L_unit_pub_ffn
  v_mov_b32 v58, s44
  v_mov_b32 v59, s45
  v_mov_b32 v62, s44
  v_mov_b32 v63, s45
  v_add_f32_dpp v56, v124, v120 row_ror:8 row_mask:0xf bank_mask:0xf
  v_add_f32_dpp v57, v125, v121 row_ror:8 row_mask:0xf bank_mask:0xf
  v_add_f32_dpp v60, v126, v122 row_ror:8 row_mask:0xf bank_mask:0xf
  v_add_f32_dpp v61, v127, v123 row_ror:8 row_mask:0xf bank_mask:0xf
  v_lshl_add_u32 v6, v5, 14, v6
  s_lshl_b32 s31, s4, 15
  s_lshl_b32 s32, s28, 12
  s_add_u32 s32, s32, s31
  s_lshl_b32 s33, s27, 9
  s_add_u32 s32, s32, s33
  s_add_u32 s32, s32, 4096
  s_getreg_b32 s39, hwreg(HW_REG_XCC_ID, 0, 4)
  v_mov_b32 v8, s39
  v_mov_b32 v9, s44
  v_mov_b32 v10, s45
  v_mov_b32 v11, s44
  s_lshl_b32 s38, s4, 9
  s_add_u32 s38, s38, 266240
  s_lshl_b32 s33, s5, 4
  s_add_u32 s33, s33, s38
  v_mov_b32 v7, 0
  s_mov_b32 exec_lo, 0x00ff00ff
  s_mov_b32 exec_hi, 0x00ff00ff
  buffer_store_dwordx4 v[56:59], v6, s[40:43], s32 offen
  buffer_store_dwordx4 v[60:63], v6, s[40:43], s32 offen offset:256
  s_mov_b64 exec, 1
  buffer_store_dwordx4 v[8:11], v7, s[40:43], s33 offen sc1
  s_mov_b64 exec, -1
  v_and_b32 v3, 31, v0
  v_lshlrev_b32 v3, 4, v3
  s_lshr_b32 s34, s5, 4
  s_lshl_b32 s34, s34, 14
  s_add_u32 s31, s31, s34
  s_add_u32 s34, s31, 4096
  s_add_u32 s35, s34, 4096
  s_add_u32 s36, s34, 8192
  s_add_u32 s37, s34, 12288
  v_lshlrev_b32 v2, 4, v0
  v_lshlrev_b32 v7, 7, v5
  v_lshl_add_u32 v7, v4, 4, v7
  v_bfe_u32 v19, v0, 3, 1
  v_lshl_add_u32 v7, v19, 3, v7
  v_bfe_u32 v19, v0, 4, 1
  v_lshl_add_u32 v7, v19, 2, v7
  v_add_u32 v7, 131072, v7
  v_mov_b32 v9, 132480
  s_mov_b32 s30, 0
  v_mov_b32 v16, s44
  v_mov_b32 v17, s45
  s_mov_b32 s63, 0
  s_waitcnt vmcnt(0)
L_qpoll:
  buffer_load_dwordx4 v[64:67], v2, s[40:43], s34 offen offset:0 sc1
  buffer_load_dwordx4 v[68:71], v2, s[40:43], s34 offen offset:1024 sc1
  buffer_load_dwordx4 v[72:75], v2, s[40:43], s34 offen offset:2048 sc1
  buffer_load_dwordx4 v[76:79], v2, s[40:43], s34 offen offset:3072 sc1
  buffer_load_dwordx4 v[80:83], v2, s[40:43], s35 offen offset:0 sc1
  buffer_load_dwordx4 v[84:87], v2, s[40:43], s35 offen offset:1024 sc1
  buffer_load_dwordx4 v[88:91], v2, s[40:43], s35 offen offset:2048 sc1
  buffer_load_dwordx4 v[92:95], v2, s[40:43], s35 offen offset:3072 sc1
  buffer_load_dwordx4 v[96:99], v2, s[40:43], s36 offen offset:0 sc1
  buffer_load_dwordx4 v[100:103], v2, s[40:43], s36 offen offset:1024 sc1
  buffer_load_dwordx4 v[104:107], v2, s[40:43], s36 offen offset:2048 sc1
  buffer_load_dwordx4 v[108:111], v2, s[40:43], s36 offen offset:3072 sc1
  buffer_load_dwordx4 v[112:115], v2, s[40:43], s37 offen offset:0 sc1
  buffer_load_dwordx4 v[116:119], v2, s[40:43], s37 offen offset:1024 sc1
  buffer_load_dwordx4 v[120:123], v2, s[40:43], s37 offen offset:2048 sc1
  buffer_load_dwordx4 v[124:127], v2, s[40:43], s37 offen offset:3072 sc1
  buffer_load_dwordx4 v[12:15], v3, s[40:43], s38 offen sc1
  s_cmp_lg_u32 s30, 0
  s_cbranch_scc1 L_qchk
  s_waitcnt vmcnt(0)
  v_xor_b32 v18, v13, v16
  v_bitop3_b32 v18, v18, v14, v17 bitop3:0xf6
  v_cmp_ne_u32 vcc, 0, v18
  s_cbranch_vccnz L_xretry
L_xgot:
  v_cmp_ne_u32 vcc, s39, v12
  s_cmp_eq_u64 vcc, 0
  s_cselect_b32 s30, 1, 2
  v_mov_b32 v10, s30
  ds_write_b32 v9, v10
  s_cmp_lg_u32 s30, 1
  s_cbranch_scc1 L_qremote
L_qchk:
  s_waitcnt vmcnt(16)
  v_xor_b32 v18, v66, v16
  v_bitop3_b32 v18, v18, v67, v17 bitop3:0xf6
  s_waitcnt vmcnt(15)
  v_bitop3_b32 v18, v18, v70, v16 bitop3:0xf6
  v_bitop3_b32 v18, v18, v71, v17 bitop3:0xf6
  s_waitcnt vmcnt(14)
  v_bitop3_b32 v18, v18, v74, v16 bitop3:0xf6
  v_bitop3_b32 v18, v18, v75, v17 bitop3:0xf6
  s_waitcnt vmcnt(13)
  v_bitop3_b32 v18, v18, v78, v16 bitop3:0xf6
  v_bitop3_b32 v18, v18, v79, v17 bitop3:0xf6
  s_waitcnt vmcnt(12)
  v_bitop3_b32 v18, v18, v82, v16 bitop3:0xf6
  v_bitop3_b32 v18, v18, v83, v17 bitop3:0xf6
  s_waitcnt vmcnt(11)
  v_bitop3_b32 v18, v18, v86, v16 bitop3:0xf6
  v_bitop3_b32 v18, v18, v87, v17 bitop3:0xf6
  s_waitcnt vmcnt(10)
  v_bitop3_b32 v18, v18, v90, v16 bitop3:0xf6
  v_bitop3_b32 v18, v18, v91, v17 bitop3:0xf6
  s_waitcnt vmcnt(9)
  v_bitop3_b32 v18, v18, v94, v16 bitop3:0xf6
  v_bitop3_b32 v18, v18, v95, v17 bitop3:0xf6
  s_waitcnt vmcnt(8)
  v_bitop3_b32 v18, v18, v98, v16 bitop3:0xf6
  v_bitop3_b32 v18, v18, v99, v17 bitop3:0xf6
  s_waitcnt vmcnt(7)
  v_bitop3_b32 v18, v18, v102, v16 bitop3:0xf6
  v_bitop3_b32 v18, v18, v103, v17 bitop3:0xf6
  s_waitcnt vmcnt(6)
  v_bitop3_b32 v18, v18, v106, v16 bitop3:0xf6
  v_bitop3_b32 v18, v18, v107, v17 bitop3:0xf6
  s_waitcnt vmcnt(5)
  v_bitop3_b32 v18, v18, v110, v16 bitop3:0xf6
  v_bitop3_b32 v18, v18, v111, v17 bitop3:0xf6
  s_waitcnt vmcnt(4)
  v_bitop3_b32 v18, v18, v114, v16 bitop3:0xf6
  v_bitop3_b32 v18, v18, v115, v17 bitop3:0xf6
  s_waitcnt vmcnt(3)
  v_bitop3_b32 v18, v18, v118, v16 bitop3:0xf6
  v_bitop3_b32 v18, v18, v119, v17 bitop3:0xf6
  s_waitcnt vmcnt(2)
  v_bitop3_b32 v18, v18, v122, v16 bitop3:0xf6
  v_bitop3_b32 v18, v18, v123, v17 bitop3:0xf6
  s_waitcnt vmcnt(1)
  v_bitop3_b32 v18, v18, v126, v16 bitop3:0xf6
  v_bitop3_b32 v18, v18, v127, v17 bitop3:0xf6
  v_cmp_ne_u32 vcc, 0, v18
  s_cbranch_vccz L_qgot
  s_add_u32 s63, s63, 1
  s_cmp_lt_u32 s63, 60000
  s_cbranch_scc1 L_qpoll
L_qgot:
  v_add_f32 v64, v64, v80
  v_add_f32 v96, v96, v112
  v_add_f32 v65, v65, v81
  v_add_f32 v97, v97, v113
  v_add_f32 v68, v68, v84
  v_add_f32 v100, v100, v116
  v_add_f32 v69, v69, v85
  v_add_f32 v101, v101, v117
  v_add_f32 v72, v72, v88
  v_add_f32 v104, v104, v120
  v_add_f32 v73, v73, v89
  v_add_f32 v105, v105, v121
  v_add_f32 v76, v76, v92
  v_add_f32 v108, v108, v124
  v_add_f32 v77, v77, v93
  v_add_f32 v109, v109, v125
  v_add_f32 v64, v64, v96
  v_add_f32 v65, v65, v97
  v_add_f32 v68, v68, v100
  v_add_f32 v69, v69, v101
  v_add_f32 v72, v72, v104
  v_add_f32 v73, v73, v105
  v_add_f32 v76, v76, v108
  v_add_f32 v77, v77, v109
  v_cvt_pk_bf16_f32 v20, v64, v65
  v_cvt_pk_bf16_f32 v21, v68, v69
  v_cvt_pk_bf16_f32 v22, v72, v73
  v_cvt_pk_bf16_f32 v23, v76, v77
  ds_write_b32 v7, v20 offset:0
  ds_write_b32 v7, v21 offset:256
  ds_write_b32 v7, v22 offset:576
  ds_write_b32 v7, v23 offset:832
  v_mov_b32 v11, 1
  s_waitcnt lgkmcnt(0)
  ds_write_b32 v9, v11 offset:4
  s_endpgm
L_xretry:
  s_add_u32 s63, s63, 1
  s_cmp_ge_u32 s63, 60000
  s_cbranch_scc1 L_xgot
  buffer_load_dwordx4 v[12:15], v3, s[40:43], s38 offen sc1
  s_waitcnt vmcnt(0)
  v_xor_b32 v18, v13, v16
  v_bitop3_b32 v18, v18, v14, v17 bitop3:0xf6
  v_cmp_ne_u32 vcc, 0, v18
  s_cbranch_vccnz L_xretry
  v_cmp_ne_u32 vcc, s39, v12
  s_cmp_eq_u64 vcc, 0
  s_cselect_b32 s30, 1, 2
  v_mov_b32 v10, s30
  ds_write_b32 v9, v10
  s_cmp_eq_u32 s30, 1
  s_cbranch_scc1 L_qpoll
L_qremote:
  s_mov_b32 exec_lo, 0x00ff00ff
  s_mov_b32 exec_hi, 0x00ff00ff
  buffer_store_dwordx4 v[56:59], v6, s[40:43], s32 offen sc1
  buffer_store_dwordx4 v[60:63], v6, s[40:43], s32 offen offset:256 sc1
  s_mov_b64 exec, -1
  s_waitcnt vmcnt(0)
  s_branch L_qpoll
L_unit_pub_ffn:
  s_and_b32 s46, s44, 0xff
  v_mov_b32 v56, s46
  s_bfe_u32 s46, s44, 0x80008
  v_mov_b32 v57, s46
  s_bfe_u32 s46, s44, 0x80010
  v_mov_b32 v58, s46
  s_lshr_b32 s46, s44, 24
  v_mov_b32 v59, s46
  s_mov_b32 s47, 0xffffff00
  v_add_f32_dpp v120, v124, v120 row_ror:8 row_mask:0xf bank_mask:0xf
  v_add_f32_dpp v121, v125, v121 row_ror:8 row_mask:0xf bank_mask:0xf
  v_add_f32_dpp v122, v126, v122 row_ror:8 row_mask:0xf bank_mask:0xf
  v_add_f32_dpp v123, v127, v123 row_ror:8 row_mask:0xf bank_mask:0xf
  v_lshl_add_u32 v6, v5, 10, v6
  s_lshl_b32 s31, s4, 14
  s_lshl_b32 s32, s38, 13
  s_add_u32 s31, s31, s32
  s_lshl_b32 s32, s28, 11
  s_add_u32 s31, s31, s32
  s_lshl_b32 s32, s27, 8
  s_add_u32 s31, s31, s32
  s_add_u32 s31, s31, 278528
  v_add_u32 v120, 0x80, v120
  v_add_u32 v121, 0x80, v121
  v_add_u32 v122, 0x80, v122
  v_add_u32 v123, 0x80, v123
  v_and_or_b32 v120, v120, s47, v56
  v_and_or_b32 v121, v121, s47, v57
  v_and_or_b32 v122, v122, s47, v58
  v_and_or_b32 v123, v123, s47, v59
  s_mov_b32 exec_lo, 0x00ff00ff
  s_mov_b32 exec_hi, 0x00ff00ff
  buffer_store_dwordx4 v[120:123], v6, s[40:43], s31 offen
  v_mov_b32 v8, 132480
  s_mov_b32 s51, 0
L_lw_3:
  ds_read_b32 v9, v8
  s_waitcnt lgkmcnt(0)
  v_readfirstlane_b32 s24, v9
  s_cmp_lg_u32 s24, 0
  s_cbranch_scc1 L_lwd_4
  s_add_u32 s51, s51, 1
  s_cmp_lt_u32 s51, 480000
  s_cbranch_scc1 L_lw_3
L_lwd_4:
  s_cmp_eq_u32 s24, 1
  s_cbranch_scc1 L_exit
  buffer_store_dwordx4 v[120:123], v6, s[40:43], s31 offen sc1
  s_endpgm
L_x:
  s_endpgm
L_T:
  s_load_dwordx2 s[16:17], s[0:1], 64
  s_load_dwordx2 s[20:21], s[0:1], 32
  s_load_dwordx2 s[56:57], s[0:1], 0
  s_load_dwordx2 s[52:53], s[0:1], 72
  s_mov_b32 s18, 1605632
  s_mov_b32 s19, 0x20000
  s_mov_b32 s22, 3670016
  s_mov_b32 s23, 0x20000
  s_mov_b32 s58, 1792
  s_mov_b32 s59, 0x20000
  s_mov_b32 s54, 1792
  s_mov_b32 s55, 0x20000
  s_sub_u32 s6, s3, 4
  s_lshr_b32 s7, s5, 2
  s_and_b32 s25, s5, 3
  s_lshl_b32 s26, s4, 3
  s_add_u32 s26, s26, s7
  v_and_b32 v1, 15, v0
  v_lshrrev_b32 v2, 4, v0
  v_mul_u32_u24 v3, 3584, v2
  v_lshl_add_u32 v3, v1, 4, v3
  v_mov_b32 v4, 2147418112
  s_cmp_eq_u32 s25, 3
  s_cselect_b32 s27, 8, 16
  v_cmp_gt_u32 vcc, s27, v1
  s_nop 1
  v_cndmask_b32 v3, v4, v3, vcc
  s_lshl_b32 s28, s25, 8
  s_lshl_b32 s29, s4, 1
  s_lshr_b32 s30, s7, 2
  s_add_u32 s29, s29, s30
  s_lshl_b32 s29, s29, 4
  s_and_b32 s31, s7, 3
  s_lshl_b32 s31, s31, 2
  s_add_u32 s31, s31, s6
  s_add_u32 s29, s29, s31
  s_mul_i32 s29, s29, 14336
  s_add_u32 s29, s29, s28
  s_lshr_b32 s32, s2, 4
  s_bfe_u32 s33, s2, 131074
  s_and_b32 s34, s2, 3
  s_cmp_lt_u32 s2, 48
  s_cbranch_scc1 L_T_k
  s_mov_b32 s32, 3
  s_bfe_u32 s33, s2, 131073
  s_and_b32 s34, s2, 1
L_T_k:
  s_lshr_b32 s35, s33, 1
  s_mul_i32 s35, s35, 896
  s_lshl_b32 s32, s32, 8
  s_add_u32 s35, s35, s32
  s_lshl_b32 s34, s34, 6
  s_add_u32 s35, s35, s34
  s_and_b32 s33, s33, 1
  s_lshl_b32 s33, s33, 3
  s_add_u32 s35, s35, s33
  v_and_b32 v5, 3, v0
  v_lshlrev_b32 v5, 4, v5
  v_bfe_u32 v6, v0, 4, 1
  v_lshl_add_u32 v5, v6, 2, v5
  v_lshrrev_b32 v6, 5, v0
  v_lshl_add_u32 v5, v6, 1, v5
  v_add_u32 v5, s35, v5
  v_mov_b32 v96, 0
  v_mov_b32 v97, 0
  v_mov_b32 v98, 0
  v_mov_b32 v99, 0
  s_and_b32 s30, s4, 1
  s_lshl_b32 s31, s30, 3
  s_sub_u32 s31, 32, s31
  s_mul_i32 s31, s31, s7
  s_lshl_b32 s36, s6, 4
  s_add_u32 s31, s31, s36
  s_lshr_b32 s36, s4, 1
  s_mul_i32 s36, s36, 7
  s_lshl_b32 s37, s30, 2
  s_add_u32 s36, s36, s37
  s_lshl_b32 s36, s36, 6
  s_add_u32 s36, s36, s31
  s_mul_i32 s38, s36, 896
  s_add_u32 s38, s38, s28
  s_and_b32 s30, s30, s6
  s_cmp_eq_u32 s30, 1
  s_cselect_b32 s36, 2, 4
  v_cmp_gt_u32 vcc, s36, v2
  s_nop 1
  v_cndmask_b32 v8, v4, v3, vcc
  s_sub_u32 s36, s36, 1
  v_min_u32 v9, s36, v2
  s_lshr_b32 s31, s31, 2
  v_add_u32 v9, s31, v9
  v_lshrrev_b32 v10, 4, v9
  v_lshlrev_b32 v10, 8, v10
  v_and_b32 v11, 1, v9
  v_lshl_add_u32 v10, v11, 7, v10
  v_bfe_u32 v11, v9, 1, 3
  v_lshl_add_u32 v10, v11, 4, v10
  v_bfe_u32 v12, v0, 3, 1
  v_lshl_add_u32 v10, v12, 10, v10
  v_and_b32 v11, 7, v0
  v_lshl_add_u32 v10, v11, 11, v10
  v_lshlrev_b32 v13, 15, v12
  v_lshl_add_u32 v13, v11, 4, v13
  v_lshl_add_u32 v13, v2, 8, v13
  v_lshlrev_b32 v14, 9, v12
  v_lshl_add_u32 v14, v11, 4, v14
  s_lshr_b32 s30, s7, 2
  s_lshl_b32 s36, s4, 16
  s_lshl_b32 s37, s30, 14
  s_add_u32 s36, s36, s37
  s_and_b32 s31, s7, 3
  s_lshl_b32 s31, s31, 2
  s_add_u32 s31, s31, s6
  s_lshl_b32 s31, s31, 10
  s_add_u32 s36, s36, s31
  s_add_u32 s36, s36, 409600
  s_lshl_b32 s37, s4, 10
  s_lshl_b32 s30, s30, 8
  s_add_u32 s37, s37, s30
  s_add_u32 s37, s37, 270336
  v_lshlrev_b32 v15, 4, v0
  s_lshl_b32 s30, s6, 10
  s_add_u32 s30, s30, 16384
  v_add_u32 v16, s30, v15
  s_cmp_eq_u32 s25, 3
  s_cselect_b32 s30, 1, 2
  s_cselect_b32 s34, 0x00ff00ff, -1
  v_lshlrev_b32 v22, s30, v2
  v_lshrrev_b32 v9, 2, v1
  v_add_u32 v22, v22, v9
  v_mul_u32_u24 v22, 4352, v22
  v_and_b32 v9, 3, v1
  v_lshl_add_u32 v22, v9, 4, v22
  s_mul_i32 s33, s25, 69632
  s_lshl_b32 s31, s26, 6
  s_add_u32 s33, s33, s31
  s_add_u32 s33, s33, 933888
  s_mul_i32 s32, s2, 4352
  s_add_u32 s32, s32, 933888
  s_lshl_b32 s39, s4, 14
  s_add_u32 s39, s39, 278528
  s_waitcnt lgkmcnt(0)
  s_load_dword s44, s[40:41], 0
  s_waitcnt lgkmcnt(0)
  s_mul_i32 s44, s44, 1664525
  s_add_u32 s44, s44, 1013904223
  s_not_b32 s45, s44
  s_and_b32 s46, s44, 0xff
  v_mov_b32 v56, s46
  s_bfe_u32 s46, s44, 0x80008
  v_mov_b32 v57, s46
  s_bfe_u32 s46, s44, 0x80010
  v_mov_b32 v58, s46
  s_lshr_b32 s46, s44, 24
  v_mov_b32 v59, s46
  s_mov_b32 s47, 0xffffff00
  v_and_b32 v52, 1, v0
  v_lshlrev_b32 v52, 4, v52
  v_mov_b32 v53, 0xffff
  v_lshlrev_b32 v52, v52, v53
  s_mov_b32 s48, 0x03030303
  s_mov_b32 s49, 0x03030303
  v_cndmask_b32 v48, 0, v52, s[48:49]
  s_lshl_b64 s[48:49], s[48:49], 2
  v_cndmask_b32 v49, 0, v52, s[48:49]
  s_lshl_b64 s[48:49], s[48:49], 2
  v_cndmask_b32 v50, 0, v52, s[48:49]
  s_lshl_b64 s[48:49], s[48:49], 2
  v_cndmask_b32 v51, 0, v52, s[48:49]
  v_mov_b32 v18, s44
  v_mov_b32 v19, s45
  v_mov_b32 v26, 132496
  v_mov_b32 v27, 1
  v_mov_b32 v60, 132484
  s_mov_b32 s51, 0
L_lw_5:
  ds_read_b32 v61, v60
  s_waitcnt lgkmcnt(0)
  v_readfirstlane_b32 s24, v61
  s_cmp_lg_u32 s24, 0
  s_cbranch_scc1 L_lwd_6
  s_add_u32 s51, s51, 1
  s_cmp_lt_u32 s51, 480000
  s_cbranch_scc1 L_lw_5
L_lwd_6:
  buffer_load_ushort v6, v5, s[56:59], 0 offen
  s_mov_b32 s63, 0
  s_cmp_ge_u32 s6, 2
  s_cbranch_scc1 L_T_s1
L_fpoll:
  buffer_load_dwordx4 v[32:35], v10, s[40:43], s39 offen sc1
  s_waitcnt vmcnt(0)
  v_xor_b32 v17, v32, v56
  v_bitop3_b32 v17, v17, v33, v57 bitop3:0xf6
  v_bitop3_b32 v17, v17, v34, v58 bitop3:0xf6
  v_bitop3_b32 v17, v17, v35, v59 bitop3:0xf6
  v_and_b32 v17, 0xff, v17
  v_cmp_ne_u32 vcc, 0, v17
  s_cbranch_vccz L_fgot
  s_add_u32 s63, s63, 1
  s_cmp_lt_u32 s63, 60000
  s_cbranch_scc1 L_fpoll
L_fgot:
  v_and_b32 v32, s47, v32
  v_and_b32 v33, s47, v33
  v_and_b32 v34, s47, v34
  v_and_b32 v35, s47, v35
  v_add_f32_dpp v32, v32, v32 quad_perm:[1,0,3,2] row_mask:0xf bank_mask:0xf
  v_add_f32_dpp v33, v33, v33 quad_perm:[1,0,3,2] row_mask:0xf bank_mask:0xf
  v_add_f32_dpp v34, v34, v34 quad_perm:[1,0,3,2] row_mask:0xf bank_mask:0xf
  v_add_f32_dpp v35, v35, v35 quad_perm:[1,0,3,2] row_mask:0xf bank_mask:0xf
  v_add_f32_dpp v32, v32, v32 quad_perm:[2,3,0,1] row_mask:0xf bank_mask:0xf
  v_add_f32_dpp v33, v33, v33 quad_perm:[2,3,0,1] row_mask:0xf bank_mask:0xf
  v_add_f32_dpp v34, v34, v34 quad_perm:[2,3,0,1] row_mask:0xf bank_mask:0xf
  v_add_f32_dpp v35, v35, v35 quad_perm:[2,3,0,1] row_mask:0xf bank_mask:0xf
  v_mov_b32_dpp v36, v32 row_half_mirror row_mask:0xf bank_mask:0xf
  v_mov_b32_dpp v37, v33 row_half_mirror row_mask:0xf bank_mask:0xf
  v_mov_b32_dpp v38, v34 row_half_mirror row_mask:0xf bank_mask:0xf
  v_mov_b32_dpp v39, v35 row_half_mirror row_mask:0xf bank_mask:0xf
  s_mov_b32 s48, 0x0f0f0f0f
  s_mov_b32 s49, 0x0f0f0f0f
  v_cndmask_b32 v40, v36, v32, s[48:49]
  v_cndmask_b32 v44, v32, v36, s[48:49]
  v_cndmask_b32 v41, v37, v33, s[48:49]
  v_cndmask_b32 v45, v33, v37, s[48:49]
  v_cndmask_b32 v42, v38, v34, s[48:49]
  v_cndmask_b32 v46, v34, v38, s[48:49]
  v_cndmask_b32 v43, v39, v35, s[48:49]
  v_cndmask_b32 v47, v35, v39, s[48:49]
  v_cvt_pk_bf16_f32 v32, v40, v41
  v_cvt_pk_bf16_f32 v33, v42, v43
  v_cvt_pk_bf16_f32 v34, v44, v45
  v_cvt_pk_bf16_f32 v35, v46, v47
  v_lshlrev_b32 v40, 16, v32
  v_and_b32 v41, 0xffff0000, v32
  v_lshlrev_b32 v42, 16, v33
  v_and_b32 v43, 0xffff0000, v33
  v_lshlrev_b32 v44, 16, v34
  v_and_b32 v45, 0xffff0000, v34
  v_lshlrev_b32 v46, 16, v35
  v_and_b32 v47, 0xffff0000, v35
  v_mov_b32 v52, 7.9788456080e-01
  v_mul_f32 v32, v40, v40
  v_mul_f32 v33, v41, v41
  v_mul_f32 v34, v42, v42
  v_mul_f32 v35, v43, v43
  v_fmamk_f32 v32, v32, 3.5677408136e-02, v52
  v_fmamk_f32 v33, v33, 3.5677408136e-02, v52
  v_fmamk_f32 v34, v34, 3.5677408136e-02, v52
  v_fmamk_f32 v35, v35, 3.5677408136e-02, v52
  v_mul_f32 v32, v32, v40
  v_mul_f32 v33, v33, v41
  v_mul_f32 v34, v34, v42
  v_mul_f32 v35, v35, v43
  v_mul_f32 v32, -2.8853900818e+00, v32
  v_mul_f32 v33, -2.8853900818e+00, v33
  v_mul_f32 v34, -2.8853900818e+00, v34
  v_mul_f32 v35, -2.8853900818e+00, v35
  v_exp_f32 v32, v32
  v_exp_f32 v33, v33
  v_exp_f32 v34, v34
  v_exp_f32 v35, v35
  v_add_f32 v32, 1.0, v32
  v_add_f32 v33, 1.0, v33
  v_add_f32 v34, 1.0, v34
  v_add_f32 v35, 1.0, v35
  v_rcp_f32 v32, v32
  v_rcp_f32 v33, v33
  v_rcp_f32 v34, v34
  v_rcp_f32 v35, v35
  v_mul_f32 v32, v32, v40
  v_mul_f32 v33, v33, v41
  v_mul_f32 v34, v34, v42
  v_mul_f32 v35, v35, v43
  v_cvt_pk_bf16_f32 v36, v32, v33
  v_cvt_pk_bf16_f32 v37, v34, v35
  v_lshlrev_b32 v32, 16, v36
  v_and_b32 v33, 0xffff0000, v36
  v_lshlrev_b32 v34, 16, v37
  v_and_b32 v35, 0xffff0000, v37
  v_mul_f32 v32, v32, v44
  v_mul_f32 v33, v33, v45
  v_mul_f32 v34, v34, v46
  v_mul_f32 v35, v35, v47
  v_cvt_pk_bf16_f32 v36, v32, v32
  v_cvt_pk_bf16_f32 v37, v33, v33
  v_cvt_pk_bf16_f32 v38, v34, v34
  v_cvt_pk_bf16_f32 v39, v35, v35
  v_and_b32 v100, v36, v48
  v_and_b32 v101, v36, v49
  v_and_b32 v102, v36, v50
  v_and_b32 v103, v36, v51
  v_and_b32 v104, v37, v48
  v_and_b32 v105, v37, v49
  v_and_b32 v106, v37, v50
  v_and_b32 v107, v37, v51
  v_and_b32 v108, v38, v48
  v_and_b32 v109, v38, v49
  v_and_b32 v110, v38, v50
  v_and_b32 v111, v38, v51
  v_and_b32 v112, v39, v48
  v_and_b32 v113, v39, v49
  v_and_b32 v114, v39, v50
  v_and_b32 v115, v39, v51
L_T_s1:
  s_waitcnt vmcnt(0)
  v_lshlrev_b32 v6, 16, v6
  s_mov_b32 s63, 0
  s_waitcnt vmcnt(0)
  s_barrier
  s_cmp_eq_u32 s6, 3
  s_cbranch_scc1 L_warm_ML
  s_cmp_ge_u32 s6, 2
  s_cbranch_scc1 L_T_nowd
  buffer_load_dwordx4 v[64:67], v8, s[16:19], s38 offen offset:0 nt
  buffer_load_dwordx4 v[68:71], v8, s[16:19], s38 offen offset:896 nt
  buffer_load_dwordx4 v[72:75], v8, s[16:19], s38 offen offset:1792 nt
  buffer_load_dwordx4 v[76:79], v8, s[16:19], s38 offen offset:2688 nt
L_T_nowd:
  buffer_load_dwordx4 v[80:83], v3, s[20:23], s29 offen offset:0 nt
  buffer_load_dwordx4 v[84:87], v3, s[20:23], s29 offen offset:896 nt
  buffer_load_dwordx4 v[88:91], v3, s[20:23], s29 offen offset:1792 nt
  buffer_load_dwordx4 v[92:95], v3, s[20:23], s29 offen offset:2688 nt
  s_cmp_ge_u32 s6, 2
  s_cbranch_scc1 L_T_nomm
  s_waitcnt vmcnt(4)
  v_mfma_f32_16x16x32_bf16 v[96:99], v[100:103], v[64:67], v[96:99]
  v_mfma_f32_16x16x32_bf16 v[96:99], v[104:107], v[68:71], v[96:99]
  v_mfma_f32_16x16x32_bf16 v[96:99], v[108:111], v[72:75], v[96:99]
  v_mfma_f32_16x16x32_bf16 v[96:99], v[112:115], v[76:79], v[96:99]
L_T_nomm:
  v_mov_b32 v60, 132492
  s_mov_b32 s51, 0
L_lw_8:
  ds_read_b32 v61, v60
  s_waitcnt lgkmcnt(0)
  v_readfirstlane_b32 s24, v61
  s_cmp_lg_u32 s24, 0
  s_cbranch_scc1 L_lwd_9
  s_add_u32 s51, s51, 1
  s_cmp_lt_u32 s51, 480000
  s_cbranch_scc1 L_lw_8
L_lwd_9:
  buffer_load_dwordx4 v[32:35], v14, s[40:43], s37 offen sc1
  buffer_load_dwordx4 v[36:39], v14, s[40:43], s37 offen offset:128 sc1
  v_mov_b32 v60, 132488
  s_mov_b32 s51, 0
L_lw_10:
  ds_read_b32 v61, v60
  s_waitcnt lgkmcnt(0)
  v_readfirstlane_b32 s24, v61
  s_cmp_ge_u32 s24, 1023
  s_cbranch_scc1 L_lwd_11
  s_add_u32 s51, s51, 1
  s_cmp_lt_u32 s51, 480000
  s_cbranch_scc1 L_lw_10
L_lwd_11:
  buffer_load_dwordx4 v[40:43], v13, s[40:43], s36 offen sc1
  buffer_load_dwordx4 v[44:47], v13, s[40:43], s36 offen offset:128 sc1
  s_waitcnt vmcnt(2)
  v_xor_b32 v17, v34, v18
  v_bitop3_b32 v17, v17, v35, v19 bitop3:0xf6
  v_bitop3_b32 v17, v17, v38, v18 bitop3:0xf6
  v_bitop3_b32 v17, v17, v39, v19 bitop3:0xf6
  v_cmp_ne_u32 vcc, 0, v17
  s_cbranch_vccnz L_mpoll
L_mgot:
  v_max_f32 v20, v32, v36
  s_nop 1
  v_max_f32_dpp v20, v20, v20 quad_perm:[1,0,3,2] row_mask:0xf bank_mask:0xf
  s_nop 1
  v_max_f32_dpp v20, v20, v20 quad_perm:[2,3,0,1] row_mask:0xf bank_mask:0xf
  s_nop 1
  v_max_f32_dpp v20, v20, v20 row_half_mirror row_mask:0xf bank_mask:0xf
  v_sub_f32 v32, v32, v20
  v_sub_f32 v36, v36, v20
  v_mul_f32 v32, 9.0168440056e-02, v32
  v_mul_f32 v36, 9.0168440056e-02, v36
  v_exp_f32 v32, v32
  v_exp_f32 v36, v36
  s_nop 0
  v_mul_f32 v21, v32, v33
  v_fmac_f32 v21, v36, v37
  s_nop 1
  v_add_f32_dpp v21, v21, v21 quad_perm:[1,0,3,2] row_mask:0xf bank_mask:0xf
  s_nop 1
  v_add_f32_dpp v21, v21, v21 quad_perm:[2,3,0,1] row_mask:0xf bank_mask:0xf
  s_nop 1
  v_add_f32_dpp v21, v21, v21 row_half_mirror row_mask:0xf bank_mask:0xf
  v_rcp_f32 v21, v21
  s_nop 0
  v_mul_f32 v20, v32, v21
  v_mul_f32 v21, v36, v21
  buffer_load_dwordx4 v[64:67], v13, s[40:43], s36 offen sc1
  buffer_load_dwordx4 v[68:71], v13, s[40:43], s36 offen offset:128 sc1
L_opoll:
  s_waitcnt vmcnt(3)
  v_xor_b32 v17, v40, v56
  v_bitop3_b32 v17, v17, v41, v57 bitop3:0xf6
  v_bitop3_b32 v17, v17, v42, v58 bitop3:0xf6
  v_bitop3_b32 v17, v17, v43, v59 bitop3:0xf6
  s_waitcnt vmcnt(2)
  v_bitop3_b32 v17, v17, v44, v56 bitop3:0xf6
  v_bitop3_b32 v17, v17, v45, v57 bitop3:0xf6
  v_bitop3_b32 v17, v17, v46, v58 bitop3:0xf6
  v_bitop3_b32 v17, v17, v47, v59 bitop3:0xf6
  v_and_b32 v17, 0xff, v17
  v_cmp_ne_u32 vcc, 0, v17
  s_cbranch_vccz L_ogA
  buffer_load_dwordx4 v[40:43], v13, s[40:43], s36 offen sc1
  buffer_load_dwordx4 v[44:47], v13, s[40:43], s36 offen offset:128 sc1
  s_waitcnt vmcnt(3)
  v_xor_b32 v17, v64, v56
  v_bitop3_b32 v17, v17, v65, v57 bitop3:0xf6
  v_bitop3_b32 v17, v17, v66, v58 bitop3:0xf6
  v_bitop3_b32 v17, v17, v67, v59 bitop3:0xf6
  s_waitcnt vmcnt(2)
  v_bitop3_b32 v17, v17, v68, v56 bitop3:0xf6
  v_bitop3_b32 v17, v17, v69, v57 bitop3:0xf6
  v_bitop3_b32 v17, v17, v70, v58 bitop3:0xf6
  v_bitop3_b32 v17, v17, v71, v59 bitop3:0xf6
  v_and_b32 v17, 0xff, v17
  v_cmp_ne_u32 vcc, 0, v17
  s_cbranch_vccz L_ogB
  buffer_load_dwordx4 v[64:67], v13, s[40:43], s36 offen sc1
  buffer_load_dwordx4 v[68:71], v13, s[40:43], s36 offen offset:128 sc1
  s_add_u32 s63, s63, 1
  s_cmp_lt_u32 s63, 60000
  s_cbranch_scc1 L_opoll
L_ogB:
  v_and_b32 v32, s47, v64
  v_and_b32 v33, s47, v65
  v_and_b32 v34, s47, v66
  v_and_b32 v35, s47, v67
  v_and_b32 v36, s47, v68
  v_and_b32 v37, s47, v69
  v_and_b32 v38, s47, v70
  v_and_b32 v39, s47, v71
  s_branch L_ogot
L_ogA:
  v_and_b32 v32, s47, v40
  v_and_b32 v33, s47, v41
  v_and_b32 v34, s47, v42
  v_and_b32 v35, s47, v43
  v_and_b32 v36, s47, v44
  v_and_b32 v37, s47, v45
  v_and_b32 v38, s47, v46
  v_and_b32 v39, s47, v47
L_ogot:
  v_mul_f32 v28, v32, v20
  v_mul_f32 v29, v33, v20
  v_mul_f32 v30, v34, v20
  v_mul_f32 v31, v35, v20
  v_fmac_f32 v28, v36, v21
  v_fmac_f32 v29, v37, v21
  v_fmac_f32 v30, v38, v21
  v_fmac_f32 v31, v39, v21
  v_add_f32_dpp v28, v28, v28 quad_perm:[1,0,3,2] row_mask:0xf bank_mask:0xf
  v_add_f32_dpp v29, v29, v29 quad_perm:[1,0,3,2] row_mask:0xf bank_mask:0xf
  v_add_f32_dpp v30, v30, v30 quad_perm:[1,0,3,2] row_mask:0xf bank_mask:0xf
  v_add_f32_dpp v31, v31, v31 quad_perm:[1,0,3,2] row_mask:0xf bank_mask:0xf
  v_add_f32_dpp v28, v28, v28 quad_perm:[2,3,0,1] row_mask:0xf bank_mask:0xf
  v_add_f32_dpp v29, v29, v29 quad_perm:[2,3,0,1] row_mask:0xf bank_mask:0xf
  v_add_f32_dpp v30, v30, v30 quad_perm:[2,3,0,1] row_mask:0xf bank_mask:0xf
  v_add_f32_dpp v31, v31, v31 quad_perm:[2,3,0,1] row_mask:0xf bank_mask:0xf
  v_add_f32_dpp v28, v28, v28 row_half_mirror row_mask:0xf bank_mask:0xf
  v_add_f32_dpp v29, v29, v29 row_half_mirror row_mask:0xf bank_mask:0xf
  v_add_f32_dpp v30, v30, v30 row_half_mirror row_mask:0xf bank_mask:0xf
  v_add_f32_dpp v31, v31, v31 row_half_mirror row_mask:0xf bank_mask:0xf
  v_cvt_pk_bf16_f32 v36, v28, v28
  v_cvt_pk_bf16_f32 v37, v29, v29
  v_cvt_pk_bf16_f32 v38, v30, v30
  v_cvt_pk_bf16_f32 v39, v31, v31
  v_and_b32 v100, v36, v48
  v_and_b32 v101, v36, v49
  v_and_b32 v102, v36, v50
  v_and_b32 v103, v36, v51
  v_and_b32 v104, v37, v48
  v_and_b32 v105, v37, v49
  v_and_b32 v106, v37, v50
  v_and_b32 v107, v37, v51
  v_mfma_f32_16x16x32_bf16 v[96:99], v[100:103], v[80:83], v[96:99]
  v_and_b32 v108, v38, v48
  v_and_b32 v109, v38, v49
  v_and_b32 v110, v38, v50
  v_and_b32 v111, v38, v51
  v_mfma_f32_16x16x32_bf16 v[96:99], v[104:107], v[84:87], v[96:99]
  v_and_b32 v112, v39, v48
  v_and_b32 v113, v39, v49
  v_and_b32 v114, v39, v50
  v_and_b32 v115, v39, v51
  v_mfma_f32_16x16x32_bf16 v[96:99], v[108:111], v[88:91], v[96:99]
  s_nop 0
  v_mfma_f32_16x16x32_bf16 v[96:99], v[112:115], v[92:95], v[96:99]
  s_cmp_eq_u32 s6, 0
  s_cbranch_scc1 L_T_sum
  s_nop 5
  ds_write_b128 v16, v[96:99]
  s_mov_b64 exec, 1
  ds_add_u32 v26, v27
  s_branch L_exit
L_T_sum:
  s_mov_b32 s51, 0
L_twait:
  ds_read_b32 v24, v26
  s_add_u32 s51, s51, 1
  s_waitcnt lgkmcnt(0)
  v_cmp_gt_u32 vcc, 3, v24
  s_cbranch_vccz L_tgo
  s_cmp_lt_u32 s51, 480000
  s_cbranch_scc1 L_twait
L_tgo:
  ds_read_b128 v[100:103], v15 offset:17408
  ds_read_b128 v[104:107], v15 offset:18432
  ds_read_b128 v[108:111], v15 offset:19456
  s_waitcnt lgkmcnt(2)
  v_add_f32 v32, v96, v100
  v_add_f32 v33, v97, v101
  v_add_f32 v34, v98, v102
  v_add_f32 v35, v99, v103
  s_waitcnt lgkmcnt(0)
  v_add_f32 v104, v104, v108
  v_add_f32 v105, v105, v109
  v_add_f32 v106, v106, v110
  v_add_f32 v107, v107, v111
  v_add_f32 v32, v32, v104
  v_add_f32 v33, v33, v105
  v_add_f32 v34, v34, v106
  v_add_f32 v35, v35, v107
  v_and_or_b32 v32, v32, s47, v56
  v_and_or_b32 v33, v33, s47, v57
  v_and_or_b32 v34, v34, s47, v58
  v_and_or_b32 v35, v35, s47, v59
  s_mov_b32 exec_lo, s34
  s_mov_b32 exec_hi, s34
  buffer_store_dwordx4 v[32:35], v22, s[40:43], s33 offen sc1
  s_mov_b64 exec, -1
  s_cmp_ge_u32 s2, 56
  s_cbranch_scc1 L_exit
  s_waitcnt vmcnt(0)
  s_mov_b32 s63, 0
  buffer_load_dwordx4 v[64:67], v15, s[40:43], s32 offen offset:0 sc1
  buffer_load_dwordx4 v[68:71], v15, s[40:43], s32 offen offset:1024 sc1
  buffer_load_dwordx4 v[72:75], v15, s[40:43], s32 offen offset:2048 sc1
  buffer_load_dwordx4 v[76:79], v15, s[40:43], s32 offen offset:3072 sc1
  s_waitcnt vmcnt(2)
  buffer_load_dwordx4 v[80:83], v15, s[40:43], s32 offen offset:0 sc1
  buffer_load_dwordx4 v[84:87], v15, s[40:43], s32 offen offset:1024 sc1
  buffer_load_dwordx4 v[88:91], v15, s[40:43], s32 offen offset:2048 sc1
  buffer_load_dwordx4 v[92:95], v15, s[40:43], s32 offen offset:3072 sc1
L_rp2:
  s_waitcnt vmcnt(7)
  v_xor_b32 v20, v64, v56
  v_bitop3_b32 v20, v20, v65, v57 bitop3:0xf6
  v_bitop3_b32 v20, v20, v66, v58 bitop3:0xf6
  v_bitop3_b32 v20, v20, v67, v59 bitop3:0xf6
  v_and_b32 v64, s47, v64
  v_and_b32 v65, s47, v65
  v_and_b32 v66, s47, v66
  v_and_b32 v67, s47, v67
  s_waitcnt vmcnt(6)
  v_bitop3_b32 v20, v20, v68, v56 bitop3:0xf6
  v_bitop3_b32 v20, v20, v69, v57 bitop3:0xf6
  v_bitop3_b32 v20, v20, v70, v58 bitop3:0xf6
  v_bitop3_b32 v20, v20, v71, v59 bitop3:0xf6
  v_and_b32 v68, s47, v68
  v_and_b32 v69, s47, v69
  v_and_b32 v70, s47, v70
  v_and_b32 v71, s47, v71
  v_add_f32 v32, v64, v68
  v_add_f32 v33, v65, v69
  v_add_f32 v34, v66, v70
  v_add_f32 v35, v67, v71
  s_waitcnt vmcnt(5)
  v_bitop3_b32 v20, v20, v72, v56 bitop3:0xf6
  v_bitop3_b32 v20, v20, v73, v57 bitop3:0xf6
  v_bitop3_b32 v20, v20, v74, v58 bitop3:0xf6
  v_bitop3_b32 v20, v20, v75, v59 bitop3:0xf6
  v_and_b32 v72, s47, v72
  v_and_b32 v73, s47, v73
  v_and_b32 v74, s47, v74
  v_and_b32 v75, s47, v75
  v_add_f32 v32, v32, v72
  v_add_f32 v33, v33, v73
  v_add_f32 v34, v34, v74
  v_add_f32 v35, v35, v75
  s_waitcnt vmcnt(4)
  v_bitop3_b32 v20, v20, v76, v56 bitop3:0xf6
  v_bitop3_b32 v20, v20, v77, v57 bitop3:0xf6
  v_bitop3_b32 v20, v20, v78, v58 bitop3:0xf6
  v_bitop3_b32 v20, v20, v79, v59 bitop3:0xf6
  v_and_b32 v76, s47, v76
  v_and_b32 v77, s47, v77
  v_and_b32 v78, s47, v78
  v_and_b32 v79, s47, v79
  v_add_f32 v32, v32, v76
  v_add_f32 v33, v33, v77
  v_add_f32 v34, v34, v78
  v_add_f32 v35, v35, v79
  v_and_b32 v20, 0xff, v20
  v_cmp_ne_u32 vcc, 0, v20
  s_cbranch_vccz L_rgot
  buffer_load_dwordx4 v[64:67], v15, s[40:43], s32 offen offset:0 sc1
  buffer_load_dwordx4 v[68:71], v15, s[40:43], s32 offen offset:1024 sc1
  buffer_load_dwordx4 v[72:75], v15, s[40:43], s32 offen offset:2048 sc1
  buffer_load_dwordx4 v[76:79], v15, s[40:43], s32 offen offset:3072 sc1
  s_waitcnt vmcnt(7)
  v_xor_b32 v20, v80, v56
  v_bitop3_b32 v20, v20, v81, v57 bitop3:0xf6
  v_bitop3_b32 v20, v20, v82, v58 bitop3:0xf6
  v_bitop3_b32 v20, v20, v83, v59 bitop3:0xf6
  v_and_b32 v80, s47, v80
  v_and_b32 v81, s47, v81
  v_and_b32 v82, s47, v82
  v_and_b32 v83, s47, v83
  s_waitcnt vmcnt(6)
  v_bitop3_b32 v20, v20, v84, v56 bitop3:0xf6
  v_bitop3_b32 v20, v20, v85, v57 bitop3:0xf6
  v_bitop3_b32 v20, v20, v86, v58 bitop3:0xf6
  v_bitop3_b32 v20, v20, v87, v59 bitop3:0xf6
  v_and_b32 v84, s47, v84
  v_and_b32 v85, s47, v85
  v_and_b32 v86, s47, v86
  v_and_b32 v87, s47, v87
  v_add_f32 v32, v80, v84
  v_add_f32 v33, v81, v85
  v_add_f32 v34, v82, v86
  v_add_f32 v35, v83, v87
  s_waitcnt vmcnt(5)
  v_bitop3_b32 v20, v20, v88, v56 bitop3:0xf6
  v_bitop3_b32 v20, v20, v89, v57 bitop3:0xf6
  v_bitop3_b32 v20, v20, v90, v58 bitop3:0xf6
  v_bitop3_b32 v20, v20, v91, v59 bitop3:0xf6
  v_and_b32 v88, s47, v88
  v_and_b32 v89, s47, v89
  v_and_b32 v90, s47, v90
  v_and_b32 v91, s47, v91
  v_add_f32 v32, v32, v88
  v_add_f32 v33, v33, v89
  v_add_f32 v34, v34, v90
  v_add_f32 v35, v35, v91
  s_waitcnt vmcnt(4)
  v_bitop3_b32 v20, v20, v92, v56 bitop3:0xf6
  v_bitop3_b32 v20, v20, v93, v57 bitop3:0xf6
  v_bitop3_b32 v20, v20, v94, v58 bitop3:0xf6
  v_bitop3_b32 v20, v20, v95, v59 bitop3:0xf6
  v_and_b32 v92, s47, v92
  v_and_b32 v93, s47, v93
  v_and_b32 v94, s47, v94
  v_and_b32 v95, s47, v95
  v_add_f32 v32, v32, v92
  v_add_f32 v33, v33, v93
  v_add_f32 v34, v34, v94
  v_add_f32 v35, v35, v95
  v_and_b32 v20, 0xff, v20
  v_cmp_ne_u32 vcc, 0, v20
  s_cbranch_vccz L_rgot
  buffer_load_dwordx4 v[80:83], v15, s[40:43], s32 offen offset:0 sc1
  buffer_load_dwordx4 v[84:87], v15, s[40:43], s32 offen offset:1024 sc1
  buffer_load_dwordx4 v[88:91], v15, s[40:43], s32 offen offset:2048 sc1
  buffer_load_dwordx4 v[92:95], v15, s[40:43], s32 offen offset:3072 sc1
  s_add_u32 s63, s63, 1
  s_cmp_lt_u32 s63, 60000
  s_cbranch_scc1 L_rp2
L_rgot:
  v_permlane32_swap_b32 v32, v33
  v_permlane32_swap_b32 v34, v35
  v_add_f32 v32, v32, v33
  v_add_f32 v34, v34, v35
  s_nop 1
  v_permlane16_swap_b32 v32, v34
  v_add_f32 v32, v32, v34
  s_nop 1
  v_add_f32_dpp v32, v32, v32 row_ror:4 row_mask:0xf bank_mask:0xf
  s_nop 1
  v_add_f32_dpp v32, v32, v32 row_ror:8 row_mask:0xf bank_mask:0xf
  v_add_f32 v32, v32, v6
  v_cvt_pk_bf16_f32 v36, v32, v32
  s_mov_b32 exec_lo, 0x000f000f
  s_mov_b32 exec_hi, 0x000f000f
  buffer_store_short v36, v5, s[52:55], 0 offen
  s_cmp_lg_u32 s2, 0
  s_cbranch_scc1 L_final_end
  v_mov_b32 v9, 0
  s_mov_b64 exec, 1
  buffer_store_dword v18, v9, s[40:43], 0 offen offset:0
L_final_end:
  s_endpgm
L_mpoll:
  buffer_load_dwordx4 v[32:35], v14, s[40:43], s37 offen sc1
  buffer_load_dwordx4 v[36:39], v14, s[40:43], s37 offen offset:128 sc1
  s_waitcnt vmcnt(0)
  v_xor_b32 v17, v34, v18
  v_bitop3_b32 v17, v17, v35, v19 bitop3:0xf6
  v_bitop3_b32 v17, v17, v38, v18 bitop3:0xf6
  v_bitop3_b32 v17, v17, v39, v19 bitop3:0xf6
  v_cmp_ne_u32 vcc, 0, v17
  s_cbranch_vccz L_mgot2
  s_add_u32 s63, s63, 1
  s_cmp_lt_u32 s63, 60000
  s_cbranch_scc1 L_mpoll
L_mgot2:
  buffer_load_dwordx4 v[40:43], v13, s[40:43], s36 offen sc1
  buffer_load_dwordx4 v[44:47], v13, s[40:43], s36 offen offset:128 sc1
  s_branch L_mgot
L_warm_ML:
  v_lshlrev_b32 v24, 5, v12
  v_add_u32 v24, 132352, v24
  v_mov_b32 v25, 132480
  ds_read_b128 v[32:35], v24
  ds_read_b128 v[36:39], v24 offset:16
  ds_read_b128 v[40:43], v24 offset:64
  ds_read_b128 v[44:47], v24 offset:80
  ds_read_b32 v25, v25
  s_lshl_b32 s30, s4, 10
  s_lshr_b32 s31, s5, 4
  s_lshl_b32 s31, s31, 9
  s_add_u32 s30, s30, s31
  s_and_b32 s31, s5, 15
  s_lshl_b32 s31, s31, 4
  s_add_u32 s30, s30, s31
  s_add_u32 s30, s30, 270336
  v_lshlrev_b32 v24, 8, v12
  v_mov_b32 v30, s44
  v_mov_b32 v31, s45
  s_waitcnt lgkmcnt(0)
  v_readfirstlane_b32 s24, v25
  v_max3_f32 v28, v32, v33, v34
  v_max3_f32 v29, v35, v36, v37
  v_max3_f32 v28, v28, v38, v39
  v_max_f32 v28, v28, v29
  v_sub_f32 v32, v32, v28
  v_sub_f32 v33, v33, v28
  v_sub_f32 v34, v34, v28
  v_sub_f32 v35, v35, v28
  v_sub_f32 v36, v36, v28
  v_sub_f32 v37, v37, v28
  v_sub_f32 v38, v38, v28
  v_sub_f32 v39, v39, v28
  v_mul_f32 v32, 9.0168440056e-02, v32
  v_mul_f32 v33, 9.0168440056e-02, v33
  v_mul_f32 v34, 9.0168440056e-02, v34
  v_mul_f32 v35, 9.0168440056e-02, v35
  v_mul_f32 v36, 9.0168440056e-02, v36
  v_mul_f32 v37, 9.0168440056e-02, v37
  v_mul_f32 v38, 9.0168440056e-02, v38
  v_mul_f32 v39, 9.0168440056e-02, v39
  v_exp_f32 v32, v32
  v_exp_f32 v33, v33
  v_exp_f32 v34, v34
  v_exp_f32 v35, v35
  v_exp_f32 v36, v36
  v_exp_f32 v37, v37
  v_exp_f32 v38, v38
  v_exp_f32 v39, v39
  s_nop 0
  v_mul_f32 v29, v32, v40
  v_fmac_f32 v29, v33, v41
  v_fmac_f32 v29, v34, v42
  v_fmac_f32 v29, v35, v43
  v_fmac_f32 v29, v36, v44
  v_fmac_f32 v29, v37, v45
  v_fmac_f32 v29, v38, v46
  v_fmac_f32 v29, v39, v47
  s_mov_b64 exec, 0x101
  s_cmp_eq_u32 s24, 1
  s_cbranch_scc1 L_ml_local
  buffer_store_dwordx4 v[28:31], v24, s[40:43], s30 offen sc1
  s_branch L_ml_done
L_ml_local:
  buffer_store_dwordx4 v[28:31], v24, s[40:43], s30 offen
L_ml_done:
  v_mov_b32 v25, 132492
  ds_write_b32 v25, v25
  s_mov_b64 exec, -1
  s_branch L_T_nowd
L_exit:
  s_endpgm
L_exit0:
  s_endpgm
.section .rodata,"a"
.p2align 6
.amdhsa_kernel parallel_sum__sliding_block_cached__geglu_ffn__decode_kernel
  .amdhsa_next_free_vgpr 128
  .amdhsa_next_free_sgpr 96
  .amdhsa_accum_offset 128
  .amdhsa_group_segment_fixed_size 0
  .amdhsa_kernarg_size 96
  .amdhsa_user_sgpr_count 2
  .amdhsa_user_sgpr_kernarg_segment_ptr 1
  .amdhsa_system_sgpr_workgroup_id_x 1
  .amdhsa_float_denorm_mode_32 3
.end_amdhsa_kernel
```
